```python
import torch

def _softmax(x, axis=-1):
    return torch.softmax(x, dim=axis)
def _gelu(x):
    return torch.nn.functional.gelu(x, approximate="tanh")
def _silu(x):
    return torch.nn.functional.silu(x)
def _sigmoid(x):
    return torch.sigmoid(x)
def _layernorm(x, axis=-1, eps=1e-5):
    m = x.mean(dim=axis, keepdim=True)
    v = x.var(dim=axis, keepdim=True, unbiased=False)
    return (x - m) / torch.sqrt(v + eps)
def _scatter_add(tgt, idx, src, axis=0):
    return tgt.clone().index_add_(axis, idx, src)
def _segment_sum(src, seg, n):
    out = torch.zeros((n,) + src.shape[1:], dtype=src.dtype)
    return out.index_add_(0, seg, src)
def _pad(x, pw):
    flat = tuple(v for pair in reversed(pw) for v in pair)
    return torch.nn.functional.pad(x, flat)

kernel_name = 'interleave_layers__sliding_block_cached__glu_gated_reglu__decode'

def setup_inputs():

    _w = (lambda a: (lambda t: t.to(torch.bfloat16) if t.is_floating_point() else t)(torch.as_tensor(a)))
    def _A_setup():
        B, Sq, D = 4, 1, 640
        Hq, Hkv, Sk, Dh = 32, 32, 4096, 128
        assert Hq % Hkv == 0, (Hq, Hkv)
        return {
            "x": _w((lambda *s: torch.randn(*s, dtype=torch.bfloat16) * 0.05)(B, Sq, D)),
            "k_cache": _w((lambda *s: torch.randn(*s, dtype=torch.bfloat16) * 0.8)(B, Hkv, Sk, Dh)),
            "v_cache": _w((lambda *s: torch.randn(*s, dtype=torch.bfloat16) * 0.8)(B, Hkv, Sk, Dh)),
            "wq": _w((lambda *s: torch.randn(*s, dtype=torch.bfloat16) * 0.8)(D, Hq * Dh) * (D ** -0.5)),
            "wo": _w((lambda *s: torch.randn(*s, dtype=torch.bfloat16) * 0.8)(Hq * Dh, D) * ((Hq * Dh) ** -0.5)),
        }
    _A_in = _A_setup()

    def _B_setup():
        B, S, D, F = 4, 1, 640, 1728
        return {
            "x": _w((lambda *s: torch.randn(*s, dtype=torch.bfloat16) * 0.05)(B, S, D)),
            "W_gate": _w((lambda *s: torch.randn(*s, dtype=torch.bfloat16) * 0.2)(D, F) * (2.0 / D) ** 0.5),
            "W_up": _w((lambda *s: torch.randn(*s, dtype=torch.bfloat16) * 0.2)(D, F) * (2.0 / D) ** 0.5),
            "W_down": _w((lambda *s: torch.randn(*s, dtype=torch.bfloat16) * 0.2)(F, D) * (1.0 / F) ** 0.5),
        }
    _B_in = _B_setup()

    return {
        "A_x": _A_in["x"],
        "A_k_cache": _A_in["k_cache"],
        "A_v_cache": _A_in["v_cache"],
        "A_wq": _A_in["wq"],
        "A_wo": _A_in["wo"],
        "B_x": _B_in["x"],
        "B_W_gate": _B_in["W_gate"],
        "B_W_up": _B_in["W_up"],
        "B_W_down": _B_in["W_down"],
    }

def reference(A_x, A_k_cache, A_v_cache, A_wq, A_wo, B_x, B_W_gate, B_W_up, B_W_down):
    def _A_ref(x, k_cache, v_cache, wq, wo):
        B, Sq, D = x.shape
        Hq, Dh = 32, 128
        Hkv, Sk = k_cache.shape[1], k_cache.shape[2]
        W = min(4096, max(256, Sk // 4))
        rep = Hq // Hkv
        q = (lambda x, *d: x.permute(*d))((x @ wq).reshape(B, Sq, Hq, Dh), 0, 2, 1, 3)
        k = (lambda x, n, axis: torch.repeat_interleave(x, n, dim=axis))(k_cache[:, :, Sk - W:, :], rep, axis=1)
        v = (lambda x, n, axis: torch.repeat_interleave(x, n, dim=axis))(v_cache[:, :, Sk - W:, :], rep, axis=1)
        scores = torch.einsum("bhqd,bhkd->bhqk", q, k) * (Dh ** -0.5)
        p = _softmax(scores, axis=-1)
        o = torch.einsum("bhqk,bhkd->bhqd", p, v)
        return (lambda x, *d: x.permute(*d))(o, 0, 2, 1, 3).reshape(B, Sq, Hq * Dh) @ wo

    def _B_ref(x, W_gate, W_up, W_down):
        gate = torch.einsum("bsd,df->bsf", x, W_gate)
        up = torch.einsum("bsd,df->bsf", x, W_up)
        gate = gate * (lambda x, dt: x.to(dt))(gate > 0, gate.dtype)
        h = gate * up
        return torch.einsum("bsf,fd->bsd", h, W_down)

    x = A_x
    x = x + _A_ref(_layernorm(x, axis=-1), A_k_cache, A_v_cache, A_wq, A_wo)
    x = x + _B_ref(_layernorm(x, axis=-1), B_W_gate, B_W_up, B_W_down)
    x = x + _A_ref(_layernorm(x, axis=-1), A_k_cache, A_v_cache, A_wq, A_wo)
    x = x + _B_ref(_layernorm(x, axis=-1), B_W_gate, B_W_up, B_W_down)
    return x
```

```asm
; @launch grid=(256,1,1) block=(256,1,1) lds=144896
.amdgcn_target "amdgcn-amd-amdhsa--gfx950"
.text
.globl interleave_layers__sliding_block_cached__glu_gated_reglu__decode_kernel
.p2align 8
.type interleave_layers__sliding_block_cached__glu_gated_reglu__decode_kernel,@function
interleave_layers__sliding_block_cached__glu_gated_reglu__decode_kernel:
    s_memrealtime s[94:95]
    s_mov_b32 s14, 0
    s_load_dwordx16 s[16:31], s[0:1], 0
    s_load_dwordx8 s[32:39], s[0:1], 64
    s_cmp_ge_u32 s2, 256
    s_cbranch_scc1 L_end
    s_getpc_b64 s[90:91]
L_pc:
    v_lshlrev_b32 v45, 4, v0
    s_lshr_b32 s71, s2, 3
    s_sub_u32 s71, 31, s71
    s_lshl_b32 s71, s71, 12
    v_add_u32 v44, s71, v45
    v_lshrrev_b32 v40, 6, v0
    s_cmp_ge_u32 s71, L_codeend-L_pc-4095
    s_cbranch_scc1 L_nopf
    global_load_dwordx4 v[56:59], v44, s[90:91]
L_nopf:
    v_readfirstlane_b32 s56, v40
    v_and_b32 v1, 63, v0
    s_and_b32 s57, s2, 7
    s_lshr_b32 s58, s2, 6
    s_bfe_u32 s59, s2, 0x30003
    s_lshl_b32 s60, s57, 2
    s_add_u32 s60, s60, s58
    s_lshl_b32 s64, s56, 15
    s_lshr_b32 s69, s59, 1
    s_lshl_b32 s69, s69, 5
    s_add_u32 s69, s69, s60
    s_lshl_b32 s69, s69, 3
    s_and_b32 s70, s59, 1
    s_add_u32 s69, s69, s70
    s_add_u32 s69, s69, 6
    s_lshl_b32 s69, s69, 17
    v_and_b32 v251, 15, v0
    v_bfe_u32 v252, v0, 4, 2
    v_bfe_u32 v43, v0, 4, 1
    v_bfe_u32 v44, v0, 5, 1
    v_lshl_or_b32 v43, v43, 1, v44
    v_xor_b32 v43, v43, v251
    v_lshlrev_b32 v43, 4, v43
    v_lshl_or_b32 v224, v252, 8, v43
    v_xor_b32 v225, 64, v224
    v_xor_b32 v226, 128, v224
    v_xor_b32 v227, 192, v224
    s_mov_b32 s42, 131072
    s_mov_b32 s43, 0x20000
    s_mov_b32 m0, s64
    s_lshl_b32 s63, s56, 10
    s_waitcnt lgkmcnt(0)
    s_add_u32 s40, s18, s69
    s_addc_u32 s41, s19, 0
    buffer_load_dwordx4 v224, s[40:43], s63 offen nt lds
    s_addk_i32 m0, 1024
    s_addk_i32 s63, 4096
    buffer_load_dwordx4 v225, s[40:43], s63 offen nt lds
    s_addk_i32 m0, 1024
    s_addk_i32 s63, 4096
    buffer_load_dwordx4 v226, s[40:43], s63 offen nt lds
    s_addk_i32 m0, 1024
    s_addk_i32 s63, 4096
    buffer_load_dwordx4 v227, s[40:43], s63 offen nt lds
    s_addk_i32 m0, 1024
    s_addk_i32 s63, 4096
    s_add_u32 s90, s38, 1556480
    s_addc_u32 s91, s39, 0
    s_load_dword s93, s[90:91], 0
    s_mov_b32 s54, 1040640
    s_mov_b32 s55, 0x20000
    s_mov_b32 s50, 1818880
    s_mov_b32 s51, 0x20000
    s_getreg_b32 s81, hwreg(HW_REG_XCC_ID, 0, 4)
    s_mul_i32 s4, s57, 94208
    s_mov_b32 s6, 94208
    s_mov_b32 s7, 0x20000
    v_lshlrev_b32 v46, 4, v1
    s_cmp_lt_u32 s59, 5
    s_cselect_b32 s61, 0, 1
    s_mov_b32 s48, s38
    s_mov_b32 s49, s39
    s_add_u32 s4, s38, s4
    s_addc_u32 s5, s39, 0
    s_lshr_b32 s71, s2, 3
    s_lshl_b32 s71, s71, 2
    s_add_u32 s71, s71, s56
    s_lshl_b32 s71, s71, 10
    s_add_u32 s71, s71, 0
    v_and_b32 v45, 7, v1
    v_lshlrev_b32 v45, 7, v45
    buffer_load_dword v83, v45, s[4:7], s71 offen
    s_lshl_b32 s71, s2, 2
    s_add_u32 s71, s71, s56
    s_and_b32 s72, s71, 0x30
    s_add_u32 s72, s72, s71
    s_lshl_b32 s72, s72, 10
    s_add_u32 s72, s72, 1425408
    s_cmp_lt_u32 s71, 64
    s_cbranch_scc1 L_pre2
    s_and_b32 s71, s71, 0x3e3
    s_cmp_lg_u32 s71, 960
    s_cbranch_scc1 L_nopre
    s_add_u32 s72, s57, 1
    s_and_b32 s72, s72, 7
    s_lshl_b32 s72, s72, 10
    s_add_u32 s72, s72, 1409024
    v_bfe_u32 v47, v1, 3, 1
    v_lshl_add_u32 v45, v47, 13, v45
L_pre2:
    buffer_load_dword v84, v45, s[48:51], s72 offen
L_nopre:
    s_cmp_eq_u32 s61, 0
    s_cbranch_scc1 L_q0
    buffer_load_dwordx4 v224, s[40:43], s63 offen nt lds
    s_addk_i32 m0, 1024
    s_addk_i32 s63, 4096
    buffer_load_dwordx4 v225, s[40:43], s63 offen nt lds
    s_addk_i32 m0, 1024
    s_addk_i32 s63, 4096
    buffer_load_dwordx4 v226, s[40:43], s63 offen nt lds
    s_addk_i32 m0, 1024
    s_addk_i32 s63, 4096
    buffer_load_dwordx4 v227, s[40:43], s63 offen nt lds
    s_addk_i32 m0, 1024
    s_addk_i32 s63, 4096
    s_cmp_lg_u32 s56, 3
    s_cbranch_scc1 L_nf_1
    s_lshr_b32 s72, s2, 3
    s_lshl_b32 s72, s72, 7
    s_add_u32 s72, s72, 87040
    s_waitcnt lgkmcnt(0)
    s_add_u32 s73, s93, 1
    s_lshl_b32 s11, s81, 24
    s_add_u32 s11, s11, s73
    v_mov_b32 v76, s81
    v_mov_b32 v77, s73
    v_mov_b32 v78, s11
    v_mov_b32 v79, s73
    v_lshlrev_b32 v80, 4, v1
    s_mov_b64 exec, 0xff
    buffer_store_dwordx4 v[76:79], v80, s[4:7], s72 offen
    s_mov_b64 exec, -1
L_nf_1:
    s_mul_i32 s82, s58, 3
    s_add_u32 s82, s82, s59
    s_sub_u32 s82, s82, 5
    s_cmp_lg_u32 s56, 2
    s_cbranch_scc1 L_tv_2
    v_and_b32 v45, 1, v1
    v_lshl_add_u32 v45, v45, 16, s69
    global_load_dword v82, v45, s[20:21] nt
L_tv_2:
    s_cmp_lt_u32 s82, 10
    s_cbranch_scc1 L_notouch
    s_mov_b32 s61, 2
    v_lshlrev_b32 v45, 17, v1
    s_cmp_eq_u32 s56, 1
    s_cbranch_scc1 L_tw_3
    s_cmp_eq_u32 s56, 3
    s_cbranch_scc1 L_tw_4
    s_cmp_eq_u32 s56, 2
    s_cbranch_scc1 L_notouch
    v_min_u32 v47, 5242876, v45
    global_load_dword v64, v47, s[24:25]
    v_min_u32 v47, 2211836, v45
    global_load_dword v65, v47, s[32:33]
    s_branch L_notouch
L_tw_3:
    v_min_u32 v47, 2211836, v45
    global_load_dword v64, v47, s[28:29]
    global_load_dword v65, v47, s[30:31]
    s_branch L_notouch
L_tw_4:
    v_min_u32 v47, 1818876, v45
    v_mov_b32 v45, 0
    global_load_dword v64, v47, s[38:39]
    global_load_dword v65, v45, s[34:35]
L_notouch:
    s_add_u32 s44, s20, s69
    s_addc_u32 s45, s21, 0
    s_mov_b32 s46, 131072
    s_mov_b32 s47, 0x20000
    v_mov_b32 v253, 0x80000000
    v_mov_b32 v28, 131072
    s_mov_b32 s80, 21504
    s_mov_b32 s67, 0
    v_mov_b32 v0, 0xff
    s_mov_b32 s85, 0x3acccccd
    s_mov_b32 s86, 0x3727c5ac
    v_and_b32 v43, 1, v1
    v_mul_u32_u24 v2, 0xaaaa, v43
    v_add_u32 v2, 0x4444, v2
    v_lshlrev_b32 v254, 4, v43
    v_lshl_or_b32 v254, v252, 5, v254
    buffer_load_dwordx4 v224, s[40:43], s63 offen nt lds
    s_addk_i32 m0, 1024
    s_addk_i32 s63, 4096
    buffer_load_dwordx4 v225, s[40:43], s63 offen nt lds
    s_addk_i32 m0, 1024
    s_addk_i32 s63, 4096
    buffer_load_dwordx4 v226, s[40:43], s63 offen nt lds
    s_addk_i32 m0, 1024
    s_addk_i32 s63, 4096
    buffer_load_dwordx4 v227, s[40:43], s63 offen nt lds
    s_addk_i32 m0, 1024
    s_addk_i32 s63, 4096
    buffer_load_dwordx4 v224, s[40:43], s63 offen nt lds
    s_addk_i32 m0, 1024
    s_addk_i32 s63, 4096
    buffer_load_dwordx4 v225, s[40:43], s63 offen nt lds
    s_addk_i32 m0, 1024
    s_addk_i32 s63, 4096
    buffer_load_dwordx4 v226, s[40:43], s63 offen nt lds
    s_addk_i32 m0, 1024
    s_addk_i32 s63, 4096
    buffer_load_dwordx4 v227, s[40:43], s63 offen nt lds
    s_addk_i32 m0, 1024
    s_addk_i32 s63, 4096
    s_waitcnt lgkmcnt(0)
    s_add_u32 s93, s93, 1
    s_mov_b32 s73, s93
    s_and_b32 s26, s93, 0xff
    s_mov_b32 s27, s26
    s_lshl_b32 s11, s81, 24
    s_add_u32 s11, s11, s93
    s_branch L_stream
L_q0:
    v_lshlrev_b32 v43, 1, v252
    v_xor_b32 v43, v43, v251
    v_lshlrev_b32 v43, 4, v43
    v_lshl_or_b32 v4, v252, 13, v43
    v_xor_b32 v5, 128, v4
    s_lshl_b32 s70, s59, 20
    s_lshl_b32 s71, s60, 8
    s_add_u32 s70, s70, s71
    s_add_u32 m0, s64, 24576
    s_lshl_b32 s63, s56, 18
    s_add_u32 s52, s22, s70
    s_addc_u32 s53, s23, 0
    s_mul_i32 s71, s56, 1280
    v_add_u32 v45, s71, v46
    v_lshl_add_u32 v47, v1, 2, s71
    global_load_dwordx4 v[60:63], v45, s[16:17]
    global_load_dword v64, v47, s[16:17] offset:1024
    v_and_b32 v43, 31, v1
    v_lshlrev_b32 v43, 3, v43
    v_lshl_or_b32 v43, v44, 2, v43
    s_lshl_b32 s72, s59, 8
    s_add_u32 s71, s71, s72
    v_add_u32 v43, s71, v43
    global_load_dword v37, v43, s[16:17]
    buffer_load_dwordx4 v4, s[52:55], s63 offen nt lds
    s_addk_i32 m0, 1024
    s_add_u32 s63, s63, 32768
    buffer_load_dwordx4 v4, s[52:55], s63 offen nt lds
    s_addk_i32 m0, 1024
    s_add_u32 s63, s63, 32768
    s_cmp_lg_u32 s56, 3
    s_cbranch_scc1 L_nf_5
    s_lshr_b32 s72, s2, 3
    s_lshl_b32 s72, s72, 7
    s_add_u32 s72, s72, 87040
    s_waitcnt lgkmcnt(0)
    s_add_u32 s73, s93, 1
    s_lshl_b32 s11, s81, 24
    s_add_u32 s11, s11, s73
    v_mov_b32 v76, s81
    v_mov_b32 v77, s73
    v_mov_b32 v78, s11
    v_mov_b32 v79, s73
    v_lshlrev_b32 v80, 4, v1
    s_mov_b64 exec, 0xff
    buffer_store_dwordx4 v[76:79], v80, s[4:7], s72 offen
    s_mov_b64 exec, -1
L_nf_5:
    buffer_load_dwordx4 v5, s[52:55], s63 offen nt lds
    s_addk_i32 m0, 1024
    s_add_u32 s63, s63, 32768
    buffer_load_dwordx4 v5, s[52:55], s63 offen nt lds
    s_addk_i32 m0, 1024
    s_add_u32 s63, s63, 32768
    buffer_load_dwordx4 v4, s[52:55], s63 offen nt lds
    s_addk_i32 m0, 1024
    s_add_u32 s63, s63, 32768
    buffer_load_dwordx4 v4, s[52:55], s63 offen nt lds
    s_addk_i32 m0, 1024
    s_add_u32 s63, s63, 32768
    buffer_load_dwordx4 v5, s[52:55], s63 offen nt lds
    s_addk_i32 m0, 1024
    s_add_u32 s63, s63, 32768
    buffer_load_dwordx4 v5, s[52:55], s63 offen nt lds
    s_addk_i32 m0, 1024
    s_add_u32 s63, s63, 32768
    s_add_u32 m0, s64, 4096
    s_lshl_b32 s63, s56, 10
    s_add_u32 s63, s63, 16384
    s_cmp_lg_u32 s56, 2
    s_cbranch_scc1 L_tv_6
    v_and_b32 v45, 1, v1
    v_lshl_add_u32 v45, v45, 16, s69
    global_load_dword v82, v45, s[20:21] nt
L_tv_6:
    s_add_u32 s44, s20, s69
    s_addc_u32 s45, s21, 0
    s_mov_b32 s46, 131072
    s_mov_b32 s47, 0x20000
    v_mov_b32 v253, 0x80000000
    v_mov_b32 v28, 131072
    s_mov_b32 s80, 21504
    s_mov_b32 s67, 0
    v_mov_b32 v0, 0xff
    s_mov_b32 s85, 0x3acccccd
    s_mov_b32 s86, 0x3727c5ac
    v_and_b32 v43, 1, v1
    v_mul_u32_u24 v2, 0xaaaa, v43
    v_add_u32 v2, 0x4444, v2
    v_lshlrev_b32 v254, 4, v43
    v_lshl_or_b32 v254, v252, 5, v254
    s_lshl_b32 s71, s58, 2
    s_add_u32 s71, s71, s56
    s_mul_i32 s72, s71, 2560
    s_lshl_b32 s70, s59, 7
    s_add_u32 s72, s72, s70
    v_mul_u32_u24 v43, 640, v252
    v_lshl_add_u32 v44, v251, 3, s72
    v_add_u32 v13, v43, v44
    v_lshrrev_b32 v45, 5, v1
    v_bfe_u32 v43, v1, 2, 3
    v_lshl_or_b32 v43, v43, 1, v45
    v_and_b32 v45, 3, v1
    v_lshl_or_b32 v43, v43, 2, v45
    s_mul_i32 s72, s56, 272
    s_add_u32 s72, s72, 131072
    v_lshl_add_u32 v11, v43, 2, s72
    v_and_b32 v45, 2, v1
    v_cmp_eq_u32 vcc, 0, v45
    v_lshrrev_b32 v43, 2, v251
    v_mov_b32 v46, 0x3f803f80
    v_lshl_add_u32 v45, v1, 2, v28
    v_cndmask_b32 v43, 4, v43, vcc
    v_mul_u32_u24 v43, 272, v43
    v_add3_u32 v12, v43, v254, v28
    ds_write_b32 v45, v46 offset:1088
    v_bfe_u32 v43, v1, 1, 4
    s_lshl_b32 s72, s56, 2
    v_xor_b32 v43, s72, v43
    v_and_b32 v44, 1, v1
    v_lshlrev_b32 v44, 3, v44
    v_bfe_u32 v40, v1, 2, 2
    v_lshl_add_u32 v43, v43, 4, v44
    v_lshl_add_u32 v43, v40, 8, v43
    v_lshl_add_u32 v43, v252, 11, v43
    v_add_u32 v72, 24576, v43
    v_xor_b32 v73, 32, v72
    v_add_u32 v74, 0x10000, v72
    v_add_u32 v75, 0x10000, v73
    v_mov_b32 v96, 0
    v_mov_b32 v97, 0
    v_mov_b32 v98, 0
    v_mov_b32 v99, 0
    v_mov_b32 v100, 0
    v_mov_b32 v101, 0
    v_mov_b32 v102, 0
    v_mov_b32 v103, 0
    buffer_load_dwordx4 v224, s[40:43], s63 offen nt lds
    s_addk_i32 m0, 1024
    s_addk_i32 s63, 4096
    buffer_load_dwordx4 v225, s[40:43], s63 offen nt lds
    s_addk_i32 m0, 1024
    s_addk_i32 s63, 4096
    buffer_load_dwordx4 v226, s[40:43], s63 offen nt lds
    s_addk_i32 m0, 1024
    s_addk_i32 s63, 4096
    buffer_load_dwordx4 v227, s[40:43], s63 offen nt lds
    s_addk_i32 m0, 1024
    s_addk_i32 s63, 4096
    s_waitcnt vmcnt(12)
    s_waitcnt lgkmcnt(0)
    s_add_u32 s93, s93, 1
    s_mov_b32 s73, s93
    s_and_b32 s26, s93, 0xff
    s_mov_b32 s27, s26
    s_lshl_b32 s11, s81, 24
    s_add_u32 s11, s11, s93
    v_mov_b32 v40, 0
    v_mov_b32 v41, 0
    v_dot2_f32_bf16 v40, v60, v46, v40
    v_dot2_f32_bf16 v41, v60, v60, v41
    v_dot2_f32_bf16 v40, v61, v46, v40
    v_dot2_f32_bf16 v41, v61, v61, v41
    v_dot2_f32_bf16 v40, v62, v46, v40
    v_dot2_f32_bf16 v41, v62, v62, v41
    v_dot2_f32_bf16 v40, v63, v46, v40
    v_dot2_f32_bf16 v41, v63, v63, v41
    v_dot2_f32_bf16 v40, v64, v46, v40
    v_dot2_f32_bf16 v41, v64, v64, v41
    v_lshlrev_b32 v30, 16, v37
    v_and_b32 v31, 0xffff0000, v37
    s_nop 0
    v_permlane32_swap_b32 v40, v41
    v_add_f32 v40, v40, v41
    s_nop 1
    v_add_f32_dpp v40, v40, v40 row_ror:8 row_mask:0xf bank_mask:0xf
    s_nop 1
    v_add_f32_dpp v40, v40, v40 row_ror:4 row_mask:0xf bank_mask:0xf
    s_nop 1
    v_add_f32_dpp v40, v40, v40 row_ror:2 row_mask:0xf bank_mask:0xf
    s_nop 1
    v_add_f32_dpp v40, v40, v40 row_ror:1 row_mask:0xf bank_mask:0xf
    s_nop 1
    v_add_f32_dpp v40, v40, v40 row_bcast:15 row_mask:0xa bank_mask:0xf
    v_mul_f32 v40, s85, v40
    s_nop 0
    v_readlane_b32 s71, v40, 31
    v_readlane_b32 s72, v40, 63
    s_nop 0
    v_mov_b32 v48, s71
    v_mov_b32 v49, s72
    v_fma_f32 v50, -v48, v48, v49
    v_max_f32 v50, 0, v50
    v_add_f32 v50, s86, v50
    v_rsq_f32 v50, v50
    v_sub_f32 v40, v30, v48
    v_sub_f32 v41, v31, v48
    v_mul_f32 v40, v40, v50
    v_mul_f32 v41, v41, v50
    v_cvt_pk_bf16_f32 v40, v40, v41
    ds_write_b32 v11, v40
    buffer_load_dwordx4 v224, s[40:43], s63 offen nt lds
    s_addk_i32 m0, 1024
    s_addk_i32 s63, 4096
    buffer_load_dwordx4 v225, s[40:43], s63 offen nt lds
    s_addk_i32 m0, 1024
    s_addk_i32 s63, 4096
    buffer_load_dwordx4 v226, s[40:43], s63 offen nt lds
    s_addk_i32 m0, 1024
    s_addk_i32 s63, 4096
    buffer_load_dwordx4 v227, s[40:43], s63 offen nt lds
    s_addk_i32 m0, 1024
    s_addk_i32 s63, 4096
    s_waitcnt vmcnt(8) lgkmcnt(0)
    s_barrier
    ds_read_b64_tr_b16 v[160:161], v72 offset:0
    ds_read_b64_tr_b16 v[162:163], v72 offset:1024
    ds_read_b64_tr_b16 v[164:165], v72 offset:32768
    ds_read_b64_tr_b16 v[166:167], v72 offset:33792
    ds_read_b64_tr_b16 v[168:169], v74 offset:0
    ds_read_b64_tr_b16 v[170:171], v74 offset:1024
    ds_read_b64_tr_b16 v[172:173], v74 offset:32768
    ds_read_b64_tr_b16 v[174:175], v74 offset:33792
    ds_read_b64_tr_b16 v[176:177], v73 offset:0
    ds_read_b64_tr_b16 v[178:179], v73 offset:1024
    ds_read_b64_tr_b16 v[180:181], v73 offset:32768
    ds_read_b64_tr_b16 v[182:183], v73 offset:33792
    ds_read_b64_tr_b16 v[184:185], v75 offset:0
    ds_read_b64_tr_b16 v[186:187], v75 offset:1024
    ds_read_b64_tr_b16 v[188:189], v75 offset:32768
    ds_read_b64_tr_b16 v[190:191], v75 offset:33792
    ds_read_b128 v[88:91], v12
    ds_read_b128 v[92:95], v12 offset:128
    buffer_load_dwordx4 v224, s[40:43], s63 offen nt lds
    s_addk_i32 m0, 1024
    s_addk_i32 s63, 4096
    buffer_load_dwordx4 v225, s[40:43], s63 offen nt lds
    s_addk_i32 m0, 1024
    s_addk_i32 s63, 4096
    s_waitcnt lgkmcnt(0)
    v_smfmac_f32_16x16x64_bf16 v[96:99], v[88:91], v[160:167], v2
    v_smfmac_f32_16x16x64_bf16 v[100:103], v[88:91], v[176:183], v2
    v_smfmac_f32_16x16x64_bf16 v[96:99], v[92:95], v[168:175], v2
    v_smfmac_f32_16x16x64_bf16 v[100:103], v[92:95], v[184:191], v2
    s_lshl_b32 s71, s58, 10
    s_add_u32 s71, s71, 87048
    s_add_u32 s90, s4, s71
    s_addc_u32 s91, s5, 0
    s_load_dword s16, s[90:91], 0
    s_load_dword s17, s[90:91], 128
    s_load_dword s18, s[90:91], 256
    s_load_dword s19, s[90:91], 384
    s_load_dword s20, s[90:91], 512
    s_load_dword s21, s[90:91], 640
    s_load_dword s22, s[90:91], 768
    s_load_dword s23, s[90:91], 896
    s_barrier
    v_and_b32 v45, 1, v1
    v_cmp_eq_u32 vcc, 0, v45
    v_add_f32 v40, v96, v97
    v_add_f32 v41, v100, v101
    v_cndmask_b32 v45, v253, v13, vcc
    v_add_f32 v32, v98, v99
    v_add_f32 v33, v102, v103
    v_bfi_b32 v40, v0, s73, v40
    v_bfi_b32 v41, v0, s73, v41
    s_nop 0
    v_mov_b32_dpp v42, v40 quad_perm:[1,1,3,3] row_mask:0xf bank_mask:0xf
    v_mov_b32_dpp v43, v41 quad_perm:[1,1,3,3] row_mask:0xf bank_mask:0xf
    buffer_load_dwordx4 v226, s[40:43], s63 offen nt lds
    s_addk_i32 m0, 1024
    s_addk_i32 s63, 4096
    buffer_load_dwordx4 v227, s[40:43], s63 offen nt lds
    s_addk_i32 m0, 1024
    s_addk_i32 s63, 4096
L_stream:
    buffer_load_dwordx4 v224, s[40:43], s63 offen nt lds
    s_addk_i32 m0, 1024
    s_addk_i32 s63, 4096
    buffer_load_dwordx4 v225, s[40:43], s63 offen nt lds
    s_addk_i32 m0, 1024
    s_addk_i32 s63, 4096
    buffer_load_dwordx4 v226, s[40:43], s63 offen nt lds
    s_addk_i32 m0, 1024
    s_addk_i32 s63, 4096
    buffer_load_dwordx4 v227, s[40:43], s63 offen nt lds
    s_addk_i32 m0, 1024
    s_addk_i32 s63, 4096
    s_cmp_lg_u32 s61, 0
    s_cbranch_scc1 L_noqd
    s_waitcnt lgkmcnt(0)
    s_mov_b32 s66, 1
    s_cmp_eq_u32 s16, s11
    s_cselect_b32 s66, s66, 0
    s_cmp_eq_u32 s17, s11
    s_cselect_b32 s66, s66, 0
    s_cmp_eq_u32 s18, s11
    s_cselect_b32 s66, s66, 0
    s_cmp_eq_u32 s19, s11
    s_cselect_b32 s66, s66, 0
    s_cmp_eq_u32 s20, s11
    s_cselect_b32 s66, s66, 0
    s_cmp_eq_u32 s21, s11
    s_cselect_b32 s66, s66, 0
    s_cmp_eq_u32 s22, s11
    s_cselect_b32 s66, s66, 0
    s_cmp_eq_u32 s23, s11
    s_cselect_b32 s66, s66, 0
    s_cmp_eq_u32 s66, 0
    s_cbranch_scc1 L_slow_7
    buffer_store_dwordx4 v[40:43], v45, s[4:7], s80 offen
L_pubd_8:
L_noqd:
    s_nop 1
    v_and_b32 v43, 1, v251
    v_bfe_u32 v44, v251, 1, 1
    v_lshl_or_b32 v43, v43, 1, v44
    v_and_or_b32 v43, v251, 12, v43
    v_xor_b32 v43, v43, v252
    v_lshl_add_u32 v43, v43, 4, s64
    v_lshl_add_u32 v228, v251, 8, v43
    v_xor_b32 v229, 64, v228
    v_xor_b32 v230, 128, v228
    v_xor_b32 v231, 192, v228
    s_mov_b32 s66, 0
    s_mov_b32 s68, 0
    s_mov_b32 s16, 240
    s_mov_b32 s17, 58
    s_cmp_eq_u32 s61, 0
    s_cselect_b32 s16, 380, s16
    s_cselect_b32 s17, 58, s17
    s_cmp_eq_u32 s61, 2
    s_cselect_b32 s17, 68, s17
    s_add_u32 s16, s16, s94
    s_mov_b32 s87, 0x3e0293ee
    s_mov_b32 s75, 0
    s_mov_b32 s76, 20480
    s_mov_b32 s77, 753664
    s_mov_b32 s78, 917504
    s_mov_b32 s79, 16384
    s_mov_b32 s92, 1425408
    s_mov_b32 s15, 84992
    v_min_u32 v250, 33, v1
    v_lshlrev_b32 v250, 7, v250
    v_add_u32 v250, 87040, v250
    v_mov_b32 v96, 0
    v_mov_b32 v97, 0
    v_mov_b32 v100, 0
    v_mov_b32 v101, 0
    v_mov_b32 v104, 0
    v_mov_b32 v105, 0
    v_mov_b32 v108, 0
    v_mov_b32 v109, 0
    v_mov_b32 v112, 0
    v_mov_b32 v113, 0
    v_mov_b32 v116, 0
    v_mov_b32 v117, 0
    v_mov_b32 v120, 0
    v_mov_b32 v121, 0
    v_mov_b32 v124, 0
    v_mov_b32 v125, 0
    v_mov_b32 v128, 0
    v_mov_b32 v129, 0
    v_mov_b32 v132, 0
    v_mov_b32 v133, 0
    v_mov_b32 v136, 0
    v_mov_b32 v137, 0
    v_mov_b32 v140, 0
    v_mov_b32 v141, 0
    v_mov_b32 v144, 0
    v_mov_b32 v145, 0
    v_mov_b32 v148, 0
    v_mov_b32 v149, 0
    v_mov_b32 v152, 0
    v_mov_b32 v153, 0
    v_mov_b32 v156, 0
    v_mov_b32 v157, 0
    s_mov_b64 exec, 0
    s_cmp_eq_u32 s56, 0
    s_cbranch_scc1 L_pad0_0
    s_cmp_eq_u32 s56, 1
    s_cbranch_scc1 L_pad1_0
    s_cmp_eq_u32 s56, 2
    s_cbranch_scc1 L_pad2_0
    s_branch L_pad3_0
L_walk_back:
    s_mov_b64 exec, -1
    v_add_u32 v19, 132608, v254
    s_lshl_b32 s70, s56, 8
    s_add_u32 s70, s70, 132864
    v_add_u32 v21, s70, v254
    v_and_b32 v43, 1, v1
    v_and_b32 v44, 56, v1
    v_lshl_or_b32 v44, v43, 2, v44
    v_bfe_u32 v45, v1, 1, 2
    v_or_b32 v44, v44, v45
    v_lshl_add_u32 v20, v44, 2, s70
    v_and_b32 v44, 7, v44
    v_lshrrev_b32 v45, 3, v1
    s_lshl_b32 s70, s58, 11
    s_lshl_b32 s72, s59, 5
    s_add_u32 s70, s70, s72
    v_lshl_add_u32 v45, v45, 8, s70
    v_lshl_add_u32 v26, v44, 2, v45
    v_bfe_u32 v40, v1, 1, 1
    v_bfe_u32 v41, v1, 2, 2
    v_lshl_or_b32 v40, v40, 2, v41
    v_lshl_or_b32 v45, v40, 1, v43
    v_lshl_or_b32 v45, v252, 5, v45
    v_cmp_eq_u32 vcc, 0, v43
    v_lshlrev_b32 v45, 1, v45
    v_add_u32 v18, 132608, v45
    s_lshl_b32 s70, s58, 9
    s_lshl_b32 s72, s59, 7
    s_add_u32 s70, s70, s72
    v_lshl_add_u32 v45, v40, 2, s70
    v_lshl_add_u32 v45, v252, 5, v45
    v_cndmask_b32 v249, v253, v45, vcc
    s_mul_i32 s72, s58, 10240
    v_lshl_add_u32 v43, v251, 3, s72
    s_lshr_b32 s70, s59, 1
    s_mul_i32 s70, s70, 640
    v_mul_u32_u24 v45, 2560, v252
    v_add3_u32 v16, v45, v43, s70
    s_mul_i32 s72, s59, 2560
    v_mul_u32_u24 v45, 640, v252
    v_add3_u32 v255, v45, v43, s72
    s_mov_b32 s8, 0x1f1f1f1f
    s_mov_b32 s9, 0x1f1f1f1f
    s_lshl_b32 s72, s58, 9
    s_add_u32 s72, s72, 82944
    v_lshl_add_u32 v43, v251, 3, s72
    v_lshl_add_u32 v45, v252, 7, v43
    v_cndmask_b32 v14, v253, v45, s[8:9]
    s_lshr_b32 s70, s59, 1
    s_lshl_b32 s70, s70, 7
    v_add_u32 v45, s70, v43
    v_cndmask_b32 v17, v253, v45, s[8:9]
    s_memrealtime s[88:89]
    s_add_u32 s16, s16, s17
    s_waitcnt lgkmcnt(0)
    s_sub_u32 s88, s88, s16
    s_lshr_b32 s18, s88, 31
    s_cmp_eq_u32 s18, 0
    s_waitcnt vmcnt(9)
    s_cbranch_scc1 L_th_9
    s_waitcnt vmcnt(4)
L_th_9:
    buffer_load_dwordx4 v224, s[40:43], s63 offen nt lds
    s_addk_i32 m0, 1024
    s_addk_i32 s63, 4096
    s_cmp_eq_u32 s18, 0
    s_waitcnt vmcnt(9)
    s_cbranch_scc1 L_th_10
    s_waitcnt vmcnt(4)
L_th_10:
    buffer_load_dwordx4 v225, s[40:43], s63 offen nt lds
    s_addk_i32 m0, 1024
    s_addk_i32 s63, 4096
    s_cmp_eq_u32 s18, 0
    s_waitcnt vmcnt(9)
    s_cbranch_scc1 L_th_11
    s_waitcnt vmcnt(4)
L_th_11:
    buffer_load_dwordx4 v226, s[40:43], s63 offen nt lds
    s_addk_i32 m0, 1024
    s_addk_i32 s63, 4096
    s_cmp_eq_u32 s18, 0
    s_waitcnt vmcnt(9)
    s_cbranch_scc1 L_th_12
    s_waitcnt vmcnt(4)
L_th_12:
    buffer_load_dwordx4 v227, s[40:43], s63 offen nt lds
    s_addk_i32 m0, 1024
    s_addk_i32 s63, 4096
    v_mov_b32 v45, 0
    ds_write_b32 v28, v45 offset:2848
    s_lshl_b32 s70, s58, 7
    s_lshl_b32 s72, s59, 3
    s_add_u32 s70, s70, s72
    v_cmp_eq_u32 vcc, 0, v1
    v_mov_b32 v45, s70
    s_nop 0
    v_cndmask_b32 v27, v253, v45, vcc
    s_lshr_b32 s70, s2, 3
    s_lshl_b32 s70, s70, 2
    s_add_u32 s70, s70, s56
    s_lshl_b32 s70, s70, 2
    v_mov_b32 v45, s70
    v_cndmask_b32 v29, v253, v45, vcc
    s_lshl_b32 s70, s56, 2
    s_add_u32 s72, s70, 133888
    v_mov_b32 v22, s72
    v_cmp_eq_u32 vcc, 63, v1
    s_add_u32 s72, s70, 133904
    v_mov_b32 v45, s72
    v_mov_b32 v23, 133936
    v_cndmask_b32 v23, v23, v45, vcc
    s_lshl_b32 s70, s56, 9
    s_add_u32 s70, s70, 134656
    v_lshl_add_u32 v24, v251, 2, s70
    v_lshl_add_u32 v24, v252, 7, v24
    v_lshlrev_b32 v25, 3, v1
    v_add_u32 v25, 134656, v25
    v_bfe_u32 v40, v1, 2, 2
    v_bfe_u32 v43, v1, 3, 1
    v_bfe_u32 v44, v1, 2, 1
    v_lshl_add_u32 v45, v252, 2, v43
    v_lshl_add_u32 v45, v44, 4, v45
    v_lshl_add_u32 v45, v45, 8, s64
    v_bfe_u32 v232, v1, 1, 1
    v_lshl_or_b32 v232, v43, 1, v232
    v_bfe_u32 v233, v1, 4, 1
    v_lshl_or_b32 v232, v233, 2, v232
    v_mov_b32 v6, v232
    v_lshl_or_b32 v232, v44, 3, v232
    v_and_b32 v44, 1, v1
    v_lshlrev_b32 v44, 3, v44
    v_lshl_add_u32 v45, v232, 4, v45
    v_add_u32 v232, v45, v44
    v_xor_b32 v233, 16, v232
    v_add_u32 v233, 512, v233
    v_xor_b32 v234, 32, v232
    v_xor_b32 v235, 32, v233
    v_xor_b32 v236, 64, v232
    v_xor_b32 v237, 64, v233
    v_xor_b32 v238, 96, v232
    v_xor_b32 v239, 96, v233
    v_xor_b32 v240, 128, v232
    v_xor_b32 v241, 128, v233
    v_xor_b32 v242, 160, v232
    v_xor_b32 v243, 160, v233
    v_xor_b32 v244, 192, v232
    v_xor_b32 v245, 192, v233
    v_xor_b32 v246, 224, v232
    v_xor_b32 v247, 224, v233
    v_lshl_add_u32 v6, v6, 4, v44
    v_lshl_add_u32 v6, v40, 7, v6
    v_lshl_add_u32 v6, v252, 10, v6
    s_cmp_lg_u32 s61, 2
    s_cbranch_scc1 L_sp1
    buffer_load_dwordx2 v[220:221], v250, s[4:7], 0 offen sc1
L_sp1:
    s_memrealtime s[88:89]
    s_add_u32 s16, s16, s17
    s_waitcnt lgkmcnt(0)
    s_sub_u32 s88, s88, s16
    s_lshr_b32 s18, s88, 31
    s_cmp_eq_u32 s18, 0
    s_waitcnt vmcnt(9)
    s_cbranch_scc1 L_th_13
    s_waitcnt vmcnt(4)
L_th_13:
    buffer_load_dwordx4 v224, s[40:43], s63 offen nt lds
    s_addk_i32 m0, 1024
    s_addk_i32 s63, 4096
    s_cmp_eq_u32 s18, 0
    s_waitcnt vmcnt(9)
    s_cbranch_scc1 L_th_14
    s_waitcnt vmcnt(4)
L_th_14:
    buffer_load_dwordx4 v225, s[40:43], s63 offen nt lds
    s_addk_i32 m0, 1024
    s_addk_i32 s63, 4096
    s_cmp_eq_u32 s18, 0
    s_waitcnt vmcnt(9)
    s_cbranch_scc1 L_th_15
    s_waitcnt vmcnt(4)
L_th_15:
    buffer_load_dwordx4 v226, s[40:43], s63 offen nt lds
    s_addk_i32 m0, 1024
    s_addk_i32 s63, 4096
    s_cmp_eq_u32 s18, 0
    s_waitcnt vmcnt(9)
    s_cbranch_scc1 L_th_16
    s_waitcnt vmcnt(4)
L_th_16:
    buffer_load_dwordx4 v227, s[40:43], s63 offen nt lds
    s_addk_i32 m0, 1024
    s_addk_i32 s63, 4096
    s_cmp_lg_u32 s61, 0
    s_cbranch_scc1 L_od_setup
    s_lshl_b32 s70, s58, 3
    s_add_u32 s70, s70, s57
    s_cmp_lt_u32 s70, 27
    s_cselect_b32 s62, 1, 0
    s_lshl_b32 s72, s59, 15
    s_lshr_b32 s71, s56, 1
    s_lshl_b32 s71, s71, 14
    s_add_u32 s72, s72, s71
    s_and_b32 s71, s56, 1
    s_lshl_b32 s71, s71, 12
    s_add_u32 s72, s72, s71
    s_and_b32 s3, s57, 1
    s_lshl_b32 s3, s3, 13
    s_mov_b32 s19, s56
    v_lshl_add_u32 v10, v1, 4, s72
    s_lshl_b32 s72, s56, 7
    s_lshl_b32 s71, s59, 3
    s_add_u32 s72, s72, s71
    s_add_u32 s72, s72, 82944
    s_lshl_b32 s71, s58, 9
    s_add_u32 s72, s72, s71
    v_and_b32 v44, 31, v1
    v_cmp_eq_u32 vcc, 31, v44
    v_lshrrev_b32 v45, 5, v1
    v_lshl_add_u32 v43, v45, 6, s72
    v_cndmask_b32 v15, v253, v43, vcc
    s_sub_u32 s10, s56, s58
    s_sub_u32 s10, s10, 1
    s_and_b32 s10, s10, 3
    s_lshl_b32 s72, s56, 5
    v_xor_b32 v6, s72, v6
    v_add_u32 v6, 0x10000, v6
    v_and_b32 v43, 7, v1
    s_lshl_b32 s72, s57, 10
    v_lshl_add_u32 v248, v43, 7, s72
    s_lshl_b32 s72, s57, 7
    s_add_u32 s72, s72, 16384
    v_writelane_b32 v248, s72, 63
    s_mul_i32 s71, s59, 442368
    s_lshl_b32 s70, s70, 7
    s_add_u32 s71, s71, s70
    s_cmp_lt_u32 s56, 3
    s_cselect_b32 s52, s28, s30
    s_cselect_b32 s53, s29, s31
    s_add_u32 s52, s52, s71
    s_addc_u32 s53, s53, 0
    s_lshr_b32 s13, s56, 1
    s_and_b32 s13, s13, s62
    s_mul_i32 s54, s13, 439040
    s_lshl_b32 s13, s13, 1
    s_mov_b32 s65, 27648
    s_movk_i32 s72, 3456
L_role_done:
    v_lshrrev_b32 v43, 3, v1
    v_and_b32 v44, 7, v1
    v_and_b32 v45, 2, v43
    v_xor_b32 v44, v44, v45
    v_mul_u32_u24 v43, s72, v43
    v_lshl_add_u32 v4, v44, 4, v43
    v_xor_b32 v44, 4, v44
    v_lshl_add_u32 v5, v44, 4, v43
    v_and_b32 v44, 1, v1
    s_sub_u32 s70, s54, 4
    v_mul_u32_u24 v44, s70, v44
    buffer_load_dword v85, v44, s[52:55], 0 offen nt
    s_cmp_lg_u32 s61, 1
    s_cbranch_scc1 L_notw
    s_lshl_b32 s70, s56, 3
    s_add_u32 s70, s70, s57
    s_min_u32 s70, s70, 26
    s_mul_i32 s70, s70, 81920
    v_and_b32 v44, 1, v1
    v_mul_u32_u24 v44, 80640, v44
    v_add_u32 v44, s70, v44
    global_load_dword v86, v44, s[32:33] nt
L_notw:
    s_memrealtime s[88:89]
    s_add_u32 s16, s16, s17
    s_waitcnt lgkmcnt(0)
    s_sub_u32 s88, s88, s16
    s_lshr_b32 s18, s88, 31
    s_cmp_eq_u32 s18, 0
    s_waitcnt vmcnt(9)
    s_cbranch_scc1 L_th_17
    s_waitcnt vmcnt(4)
L_th_17:
    buffer_load_dwordx4 v224, s[40:43], s63 offen nt lds
    s_addk_i32 m0, 1024
    s_addk_i32 s63, 4096
    s_cmp_eq_u32 s18, 0
    s_waitcnt vmcnt(9)
    s_cbranch_scc1 L_th_18
    s_waitcnt vmcnt(4)
L_th_18:
    buffer_load_dwordx4 v225, s[40:43], s63 offen nt lds
    s_addk_i32 m0, 1024
    s_addk_i32 s63, 4096
    s_cmp_eq_u32 s18, 0
    s_waitcnt vmcnt(9)
    s_cbranch_scc1 L_th_19
    s_waitcnt vmcnt(4)
L_th_19:
    buffer_load_dwordx4 v226, s[40:43], s63 offen nt lds
    s_addk_i32 m0, 1024
    s_addk_i32 s63, 4096
    s_cmp_eq_u32 s18, 0
    s_waitcnt vmcnt(9)
    s_cbranch_scc1 L_th_20
    s_waitcnt vmcnt(4)
L_th_20:
    buffer_load_dwordx4 v227, s[40:43], s63 offen nt lds
    s_addk_i32 m0, 1024
    s_addk_i32 s63, 4096
    s_waitcnt vmcnt(25)
    ds_read_b128 a[0:3], v228 offset:0
    ds_read_b128 a[4:7], v229 offset:0
    ds_read_b128 a[8:11], v230 offset:0
    ds_read_b128 a[12:15], v231 offset:0
    ds_read_b128 a[16:19], v228 offset:4096
    ds_read_b128 a[20:23], v229 offset:4096
    ds_read_b128 a[24:27], v230 offset:4096
    ds_read_b128 a[28:31], v231 offset:4096
    s_waitcnt lgkmcnt(0)
    s_cmp_lg_u32 s61, 2
    s_cbranch_scc1 L_sp2
    s_waitcnt vmcnt(9)
    v_cmp_ne_u32 vcc, s93, v221
    v_cmp_ne_u32 s[90:91], s81, v220
    s_or_b32 s71, vcc_lo, s90
    s_cselect_b32 s66, 0, 1
    s_sub_u32 s71, s82, 10
    s_lshl_b32 s71, s71, 2
    s_add_u32 s71, s71, s56
    s_mul_i32 s71, s71, 3072
    v_mov_b32 v40, -1
    v_mov_b32 v41, -1
    v_mov_b32 v42, -1
    v_mov_b32 v43, -1
    v_lshlrev_b32 v44, 4, v1
    s_mov_b32 s6, 21504
    s_cmp_eq_u32 s66, 0
    s_cbranch_scc1 L_slow_21
    buffer_store_dwordx4 v[40:43], v44, s[4:7], s71 offen offset:0
    buffer_store_dwordx4 v[40:43], v44, s[4:7], s71 offen offset:1024
    buffer_store_dwordx4 v[40:43], v44, s[4:7], s71 offen offset:2048
L_pubd_22:
    s_mov_b32 s6, 94208
L_sp2:
    s_memrealtime s[88:89]
    s_add_u32 s16, s16, s17
    s_waitcnt lgkmcnt(0)
    s_sub_u32 s88, s88, s16
    s_lshr_b32 s18, s88, 31
    s_cmp_eq_u32 s18, 0
    s_waitcnt vmcnt(9)
    s_cbranch_scc1 L_th_23
    s_waitcnt vmcnt(4)
L_th_23:
    s_mov_b32 m0, s64
    s_lshl_b32 s63, s56, 10
    buffer_load_dwordx4 v224, s[44:47], s63 offen nt lds
    s_addk_i32 m0, 1024
    s_addk_i32 s63, 4096
    s_cmp_eq_u32 s18, 0
    s_waitcnt vmcnt(9)
    s_cbranch_scc1 L_th_24
    s_waitcnt vmcnt(4)
L_th_24:
    buffer_load_dwordx4 v225, s[44:47], s63 offen nt lds
    s_addk_i32 m0, 1024
    s_addk_i32 s63, 4096
    s_cmp_eq_u32 s18, 0
    s_waitcnt vmcnt(9)
    s_cbranch_scc1 L_th_25
    s_waitcnt vmcnt(4)
L_th_25:
    buffer_load_dwordx4 v224, s[44:47], s63 offen nt lds
    s_addk_i32 m0, 1024
    s_addk_i32 s63, 4096
    s_cmp_eq_u32 s18, 0
    s_waitcnt vmcnt(9)
    s_cbranch_scc1 L_th_26
    s_waitcnt vmcnt(4)
L_th_26:
    buffer_load_dwordx4 v225, s[44:47], s63 offen nt lds
    s_addk_i32 m0, 1024
    s_addk_i32 s63, 4096
    s_memrealtime s[88:89]
    s_add_u32 s16, s16, s17
    s_waitcnt lgkmcnt(0)
    s_sub_u32 s88, s88, s16
    s_lshr_b32 s18, s88, 31
    s_cmp_eq_u32 s18, 0
    s_waitcnt vmcnt(9)
    s_cbranch_scc1 L_th_27
    s_waitcnt vmcnt(4)
L_th_27:
    buffer_load_dwordx4 v226, s[44:47], s63 offen nt lds
    s_addk_i32 m0, 1024
    s_addk_i32 s63, 4096
    s_cmp_eq_u32 s18, 0
    s_waitcnt vmcnt(9)
    s_cbranch_scc1 L_th_28
    s_waitcnt vmcnt(4)
L_th_28:
    buffer_load_dwordx4 v227, s[44:47], s63 offen nt lds
    s_addk_i32 m0, 1024
    s_addk_i32 s63, 4096
    s_cmp_eq_u32 s18, 0
    s_waitcnt vmcnt(9)
    s_cbranch_scc1 L_th_29
    s_waitcnt vmcnt(4)
L_th_29:
    buffer_load_dwordx4 v226, s[44:47], s63 offen nt lds
    s_addk_i32 m0, 1024
    s_addk_i32 s63, 4096
    s_cmp_eq_u32 s18, 0
    s_waitcnt vmcnt(9)
    s_cbranch_scc1 L_th_30
    s_waitcnt vmcnt(4)
L_th_30:
    buffer_load_dwordx4 v227, s[44:47], s63 offen nt lds
    s_addk_i32 m0, 1024
    s_addk_i32 s63, 4096
    s_waitcnt vmcnt(25)
    ds_read_b128 a[32:35], v228 offset:8192
    ds_read_b128 a[36:39], v229 offset:8192
    ds_read_b128 a[40:43], v230 offset:8192
    ds_read_b128 a[44:47], v231 offset:8192
    ds_read_b128 a[48:51], v228 offset:12288
    ds_read_b128 a[52:55], v229 offset:12288
    ds_read_b128 a[56:59], v230 offset:12288
    ds_read_b128 a[60:63], v231 offset:12288
    s_waitcnt lgkmcnt(0)
    s_cmp_lg_u32 s61, 2
    s_cbranch_scc1 L_sp3
    s_waitcnt vmcnt(8)
    s_barrier
    s_cmp_lg_u32 s56, 3
    s_cbranch_scc1 L_nf_31
    s_lshr_b32 s72, s2, 3
    s_lshl_b32 s72, s72, 7
    s_add_u32 s72, s72, 87296
    v_mov_b32 v76, s81
    v_mov_b32 v77, s73
    v_mov_b32 v78, s11
    v_mov_b32 v79, s73
    v_lshlrev_b32 v80, 4, v1
    s_mov_b64 exec, 0xff
    s_cmp_eq_u32 s66, 0
    s_cbranch_scc1 L_slow_32
    buffer_store_dwordx4 v[76:79], v80, s[4:7], s72 offen
L_pubd_33:
    s_mov_b64 exec, -1
L_nf_31:
L_sp3:
    s_memrealtime s[88:89]
    s_add_u32 s16, s16, s17
    s_waitcnt lgkmcnt(0)
    s_sub_u32 s88, s88, s16
    s_lshr_b32 s18, s88, 31
    s_cmp_eq_u32 s18, 0
    s_waitcnt vmcnt(9)
    s_cbranch_scc1 L_th_34
    s_waitcnt vmcnt(4)
L_th_34:
    buffer_load_dwordx4 v224, s[44:47], s63 offen nt lds
    s_addk_i32 m0, 1024
    s_addk_i32 s63, 4096
    s_cmp_eq_u32 s18, 0
    s_waitcnt vmcnt(9)
    s_cbranch_scc1 L_th_35
    s_waitcnt vmcnt(4)
L_th_35:
    buffer_load_dwordx4 v225, s[44:47], s63 offen nt lds
    s_addk_i32 m0, 1024
    s_addk_i32 s63, 4096
    s_cmp_eq_u32 s18, 0
    s_waitcnt vmcnt(9)
    s_cbranch_scc1 L_th_36
    s_waitcnt vmcnt(4)
L_th_36:
    buffer_load_dwordx4 v224, s[44:47], s63 offen nt lds
    s_addk_i32 m0, 1024
    s_addk_i32 s63, 4096
    s_cmp_eq_u32 s18, 0
    s_waitcnt vmcnt(9)
    s_cbranch_scc1 L_th_37
    s_waitcnt vmcnt(4)
L_th_37:
    buffer_load_dwordx4 v225, s[44:47], s63 offen nt lds
    s_addk_i32 m0, 1024
    s_addk_i32 s63, 4096
    s_memrealtime s[88:89]
    s_add_u32 s16, s16, s17
    s_waitcnt lgkmcnt(0)
    s_sub_u32 s88, s88, s16
    s_lshr_b32 s18, s88, 31
    s_cmp_eq_u32 s18, 0
    s_waitcnt vmcnt(9)
    s_cbranch_scc1 L_th_38
    s_waitcnt vmcnt(4)
L_th_38:
    buffer_load_dwordx4 v226, s[44:47], s63 offen nt lds
    s_addk_i32 m0, 1024
    s_addk_i32 s63, 4096
    s_cmp_eq_u32 s18, 0
    s_waitcnt vmcnt(9)
    s_cbranch_scc1 L_th_39
    s_waitcnt vmcnt(4)
L_th_39:
    buffer_load_dwordx4 v227, s[44:47], s63 offen nt lds
    s_addk_i32 m0, 1024
    s_addk_i32 s63, 4096
    s_cmp_eq_u32 s18, 0
    s_waitcnt vmcnt(9)
    s_cbranch_scc1 L_th_40
    s_waitcnt vmcnt(4)
L_th_40:
    buffer_load_dwordx4 v226, s[44:47], s63 offen nt lds
    s_addk_i32 m0, 1024
    s_addk_i32 s63, 4096
    s_cmp_eq_u32 s18, 0
    s_waitcnt vmcnt(9)
    s_cbranch_scc1 L_th_41
    s_waitcnt vmcnt(4)
L_th_41:
    buffer_load_dwordx4 v227, s[44:47], s63 offen nt lds
    s_addk_i32 m0, 1024
    s_addk_i32 s63, 4096
    s_waitcnt vmcnt(25)
    ds_read_b128 a[64:67], v228 offset:16384
    ds_read_b128 a[68:71], v229 offset:16384
    ds_read_b128 a[72:75], v230 offset:16384
    ds_read_b128 a[76:79], v231 offset:16384
    ds_read_b128 a[80:83], v228 offset:20480
    ds_read_b128 a[84:87], v229 offset:20480
    ds_read_b128 a[88:91], v230 offset:20480
    ds_read_b128 a[92:95], v231 offset:20480
    s_waitcnt lgkmcnt(0)
    s_cmp_lg_u32 s56, 0
    s_cbranch_scc1 L_gi_42
    buffer_load_dwordx2 v[56:57], v16, s[4:7], s80 offen offset:0 sc1
    buffer_load_dwordx2 v[58:59], v16, s[4:7], s80 offen offset:128 sc1
    buffer_load_dwordx2 v[60:61], v16, s[4:7], s80 offen offset:256 sc1
    buffer_load_dwordx2 v[62:63], v16, s[4:7], s80 offen offset:384 sc1
    buffer_load_dwordx2 v[64:65], v16, s[4:7], s80 offen offset:512 sc1
L_gi_42:
    s_memrealtime s[88:89]
    s_add_u32 s16, s16, s17
    s_waitcnt lgkmcnt(0)
    s_sub_u32 s88, s88, s16
    s_lshr_b32 s18, s88, 31
    s_cmp_eq_u32 s18, 0
    s_waitcnt vmcnt(9)
    s_cbranch_scc1 L_th_43
    s_waitcnt vmcnt(4)
L_th_43:
    buffer_load_dwordx4 v224, s[44:47], s63 offen nt lds
    s_addk_i32 m0, 1024
    s_addk_i32 s63, 4096
    s_cmp_eq_u32 s18, 0
    s_waitcnt vmcnt(9)
    s_cbranch_scc1 L_th_44
    s_waitcnt vmcnt(4)
L_th_44:
    buffer_load_dwordx4 v225, s[44:47], s63 offen nt lds
    s_addk_i32 m0, 1024
    s_addk_i32 s63, 4096
    s_cmp_eq_u32 s18, 0
    s_waitcnt vmcnt(9)
    s_cbranch_scc1 L_th_45
    s_waitcnt vmcnt(4)
L_th_45:
    buffer_load_dwordx4 v224, s[44:47], s63 offen nt lds
    s_addk_i32 m0, 1024
    s_addk_i32 s63, 4096
    s_cmp_eq_u32 s18, 0
    s_waitcnt vmcnt(9)
    s_cbranch_scc1 L_th_46
    s_waitcnt vmcnt(4)
L_th_46:
    buffer_load_dwordx4 v225, s[44:47], s63 offen nt lds
    s_addk_i32 m0, 1024
    s_addk_i32 s63, 4096
    s_waitcnt vmcnt(12)
    ds_read_b64_tr_b16 a[128:129], v232 offset:0
    ds_read_b64_tr_b16 a[130:131], v233 offset:0
    ds_read_b64_tr_b16 a[144:145], v234 offset:0
    ds_read_b64_tr_b16 a[146:147], v235 offset:0
    ds_read_b64_tr_b16 a[160:161], v236 offset:0
    ds_read_b64_tr_b16 a[162:163], v237 offset:0
    ds_read_b64_tr_b16 a[176:177], v238 offset:0
    ds_read_b64_tr_b16 a[178:179], v239 offset:0
    ds_read_b64_tr_b16 a[192:193], v240 offset:0
    ds_read_b64_tr_b16 a[194:195], v241 offset:0
    ds_read_b64_tr_b16 a[208:209], v242 offset:0
    ds_read_b64_tr_b16 a[210:211], v243 offset:0
    ds_read_b64_tr_b16 a[224:225], v244 offset:0
    ds_read_b64_tr_b16 a[226:227], v245 offset:0
    ds_read_b64_tr_b16 a[240:241], v246 offset:0
    ds_read_b64_tr_b16 a[242:243], v247 offset:0
    s_memrealtime s[88:89]
    s_add_u32 s16, s16, s17
    s_waitcnt lgkmcnt(0)
    s_sub_u32 s88, s88, s16
    s_lshr_b32 s18, s88, 31
    s_cmp_eq_u32 s18, 0
    s_waitcnt vmcnt(9)
    s_cbranch_scc1 L_th_47
    s_waitcnt vmcnt(4)
L_th_47:
    buffer_load_dwordx4 v226, s[44:47], s63 offen nt lds
    s_addk_i32 m0, 1024
    s_addk_i32 s63, 4096
    s_cmp_eq_u32 s18, 0
    s_waitcnt vmcnt(9)
    s_cbranch_scc1 L_th_48
    s_waitcnt vmcnt(4)
L_th_48:
    buffer_load_dwordx4 v227, s[44:47], s63 offen nt lds
    s_addk_i32 m0, 1024
    s_addk_i32 s63, 4096
    s_cmp_eq_u32 s18, 0
    s_waitcnt vmcnt(9)
    s_cbranch_scc1 L_th_49
    s_waitcnt vmcnt(4)
L_th_49:
    buffer_load_dwordx4 v226, s[44:47], s63 offen nt lds
    s_addk_i32 m0, 1024
    s_addk_i32 s63, 4096
    s_cmp_eq_u32 s18, 0
    s_waitcnt vmcnt(9)
    s_cbranch_scc1 L_th_50
    s_waitcnt vmcnt(4)
L_th_50:
    buffer_load_dwordx4 v227, s[44:47], s63 offen nt lds
    s_addk_i32 m0, 1024
    s_addk_i32 s63, 4096
    s_waitcnt vmcnt(24)
    ds_read_b128 a[96:99], v228 offset:24576
    ds_read_b128 a[100:103], v229 offset:24576
    ds_read_b128 a[104:107], v230 offset:24576
    ds_read_b128 a[108:111], v231 offset:24576
    ds_read_b128 a[112:115], v228 offset:28672
    ds_read_b128 a[116:119], v229 offset:28672
    ds_read_b128 a[120:123], v230 offset:28672
    ds_read_b128 a[124:127], v231 offset:28672
    s_waitcnt lgkmcnt(0)
    buffer_load_dwordx2 v[220:221], v250, s[4:7], 0 offen sc1
    s_memrealtime s[88:89]
    s_add_u32 s16, s16, s17
    s_waitcnt lgkmcnt(0)
    s_sub_u32 s88, s88, s16
    s_lshr_b32 s18, s88, 31
    s_cmp_eq_u32 s18, 0
    s_waitcnt vmcnt(9)
    s_cbranch_scc1 L_th_51
    s_waitcnt vmcnt(4)
L_th_51:
    buffer_load_dwordx4 v224, s[44:47], s63 offen nt lds
    s_addk_i32 m0, 1024
    s_addk_i32 s63, 4096
    s_cmp_eq_u32 s18, 0
    s_waitcnt vmcnt(9)
    s_cbranch_scc1 L_th_52
    s_waitcnt vmcnt(4)
L_th_52:
    buffer_load_dwordx4 v225, s[44:47], s63 offen nt lds
    s_addk_i32 m0, 1024
    s_addk_i32 s63, 4096
    s_cmp_eq_u32 s18, 0
    s_waitcnt vmcnt(9)
    s_cbranch_scc1 L_th_53
    s_waitcnt vmcnt(4)
L_th_53:
    buffer_load_dwordx4 v224, s[44:47], s63 offen nt lds
    s_addk_i32 m0, 1024
    s_addk_i32 s63, 4096
    s_cmp_eq_u32 s18, 0
    s_waitcnt vmcnt(9)
    s_cbranch_scc1 L_th_54
    s_waitcnt vmcnt(4)
L_th_54:
    buffer_load_dwordx4 v225, s[44:47], s63 offen nt lds
    s_addk_i32 m0, 1024
    s_addk_i32 s63, 4096
    s_waitcnt vmcnt(13)
    ds_read_b64_tr_b16 a[132:133], v232 offset:8192
    ds_read_b64_tr_b16 a[134:135], v233 offset:8192
    ds_read_b64_tr_b16 a[148:149], v234 offset:8192
    ds_read_b64_tr_b16 a[150:151], v235 offset:8192
    ds_read_b64_tr_b16 a[164:165], v236 offset:8192
    ds_read_b64_tr_b16 a[166:167], v237 offset:8192
    ds_read_b64_tr_b16 a[180:181], v238 offset:8192
    ds_read_b64_tr_b16 a[182:183], v239 offset:8192
    ds_read_b64_tr_b16 a[196:197], v240 offset:8192
    ds_read_b64_tr_b16 a[198:199], v241 offset:8192
    ds_read_b64_tr_b16 a[212:213], v242 offset:8192
    ds_read_b64_tr_b16 a[214:215], v243 offset:8192
    ds_read_b64_tr_b16 a[228:229], v244 offset:8192
    ds_read_b64_tr_b16 a[230:231], v245 offset:8192
    ds_read_b64_tr_b16 a[244:245], v246 offset:8192
    ds_read_b64_tr_b16 a[246:247], v247 offset:8192
    buffer_load_dwordx4 v226, s[44:47], s63 offen nt lds
    s_addk_i32 m0, 1024
    s_addk_i32 s63, 4096
    buffer_load_dwordx4 v227, s[44:47], s63 offen nt lds
    s_addk_i32 m0, 1024
    s_addk_i32 s63, 4096
    buffer_load_dwordx4 v226, s[44:47], s63 offen nt lds
    s_addk_i32 m0, 1024
    s_addk_i32 s63, 4096
    buffer_load_dwordx4 v227, s[44:47], s63 offen nt lds
    s_addk_i32 m0, 1024
    s_addk_i32 s63, 4096
    s_waitcnt lgkmcnt(0)
    s_cmp_eq_u32 s13, 0
    s_cbranch_scc1 L_tr_55
    s_mov_b32 m0, s64
    s_mov_b32 s63, 0
    buffer_load_dwordx4 v4, s[52:55], s63 offen nt lds
    s_addk_i32 m0, 1024
    s_add_u32 s63, s63, s65
    buffer_load_dwordx4 v5, s[52:55], s63 offen nt lds
    s_addk_i32 m0, 1024
    s_add_u32 s63, s63, s65
    buffer_load_dwordx4 v4, s[52:55], s63 offen nt lds
    s_addk_i32 m0, 1024
    s_add_u32 s63, s63, s65
    buffer_load_dwordx4 v5, s[52:55], s63 offen nt lds
    s_addk_i32 m0, 1024
    s_add_u32 s63, s63, s65
    buffer_load_dwordx4 v4, s[52:55], s63 offen nt lds
    s_addk_i32 m0, 1024
    s_add_u32 s63, s63, s65
    buffer_load_dwordx4 v5, s[52:55], s63 offen nt lds
    s_addk_i32 m0, 1024
    s_add_u32 s63, s63, s65
    buffer_load_dwordx4 v4, s[52:55], s63 offen nt lds
    s_addk_i32 m0, 1024
    s_add_u32 s63, s63, s65
    buffer_load_dwordx4 v5, s[52:55], s63 offen nt lds
    s_addk_i32 m0, 1024
    s_add_u32 s63, s63, s65
L_tr_55:
    s_cmp_eq_u32 s13, 1
    s_waitcnt vmcnt(25)
    s_cbranch_scc1 L_w2_56
    s_cmp_eq_u32 s13, 2
    s_waitcnt vmcnt(25)
    s_cbranch_scc1 L_w2_56
    s_waitcnt vmcnt(17)
L_w2_56:
    s_cmp_lg_u32 s56, 0
    s_cbranch_scc1 L_ai_j_57
L_a0c_58:
    v_xor_b32 v56, s27, v56
    v_xor_b32 v57, s27, v57
    v_xor_b32 v58, s27, v58
    v_xor_b32 v59, s27, v59
    v_pk_add_f32 v[40:41], v[56:57], v[58:59]
    v_or3_b32 v52, v56, v57, v58
    v_xor_b32 v60, s27, v60
    v_xor_b32 v61, s27, v61
    v_pk_add_f32 v[40:41], v[40:41], v[60:61]
    v_or3_b32 v52, v52, v59, v60
    v_xor_b32 v62, s27, v62
    v_xor_b32 v63, s27, v63
    v_pk_add_f32 v[40:41], v[40:41], v[62:63]
    v_or3_b32 v52, v52, v61, v62
    v_xor_b32 v64, s27, v64
    v_xor_b32 v65, s27, v65
    v_or3_b32 v52, v52, v63, v64
    v_pk_add_f32 v[40:41], v[40:41], v[64:65]
    v_bitop3_b32 v52, v52, v65, v0 bitop3:0xa8
    v_cmp_ne_u32 vcc, 0, v52
    s_cbranch_vccnz L_a0r_59
L_a0k_61:
    v_cvt_pk_bf16_f32 v40, v40, v41
    ds_write_b16 v18, v40
    ds_write_b16_d16_hi v18, v40 offset:32
L_ai_j_57:
    s_waitcnt lgkmcnt(0)
    s_barrier
    ds_read_b128 v[88:91], v19
    ds_read_b128 v[92:95], v19 offset:128
    s_waitcnt lgkmcnt(1)
    v_smfmac_f32_16x16x64_bf16 v[96:99], v[88:91], a[0:7], v2
    v_smfmac_f32_16x16x64_bf16 v[100:103], v[88:91], a[16:23], v2
    s_waitcnt lgkmcnt(0)
    v_smfmac_f32_16x16x64_bf16 v[96:99], v[92:95], a[8:15], v2
    v_smfmac_f32_16x16x64_bf16 v[100:103], v[92:95], a[24:31], v2
    v_smfmac_f32_16x16x64_bf16 v[104:107], v[88:91], a[32:39], v2
    v_smfmac_f32_16x16x64_bf16 v[104:107], v[92:95], a[40:47], v2
    v_smfmac_f32_16x16x64_bf16 v[108:111], v[88:91], a[48:55], v2
    v_smfmac_f32_16x16x64_bf16 v[108:111], v[92:95], a[56:63], v2
    v_smfmac_f32_16x16x64_bf16 v[112:115], v[88:91], a[64:71], v2
    v_smfmac_f32_16x16x64_bf16 v[112:115], v[92:95], a[72:79], v2
    v_smfmac_f32_16x16x64_bf16 v[116:119], v[88:91], a[80:87], v2
    v_smfmac_f32_16x16x64_bf16 v[116:119], v[92:95], a[88:95], v2
    v_add_f32 v96, v96, v97
    v_add_f32 v100, v100, v101
    v_smfmac_f32_16x16x64_bf16 v[120:123], v[88:91], a[96:103], v2
    v_smfmac_f32_16x16x64_bf16 v[120:123], v[92:95], a[104:111], v2
    v_add_f32 v104, v104, v105
    v_smfmac_f32_16x16x64_bf16 v[124:127], v[88:91], a[112:119], v2
    v_smfmac_f32_16x16x64_bf16 v[124:127], v[92:95], a[120:127], v2
    v_add_f32 v108, v108, v109
    v_max3_f32 v40, v96, v100, v104
    v_add_f32 v112, v112, v113
    v_add_f32 v116, v116, v117
    v_max3_f32 v40, v40, v108, v112
    v_add_f32 v120, v120, v121
    v_max3_f32 v40, v40, v116, v120
    s_nop 0
    v_add_f32 v124, v124, v125
    v_max_f32 v40, v40, v124
    v_mov_b32_dpp v96, v104 quad_perm:[0,1,2,3] row_mask:0x2 bank_mask:0xf
    v_mov_b32_dpp v100, v108 quad_perm:[0,1,2,3] row_mask:0x2 bank_mask:0xf
    v_max_f32_dpp v40, v40, v40 row_ror:8 row_mask:0xf bank_mask:0xf
    v_mov_b32_dpp v96, v112 quad_perm:[0,1,2,3] row_mask:0x4 bank_mask:0xf
    v_mov_b32_dpp v100, v116 quad_perm:[0,1,2,3] row_mask:0x4 bank_mask:0xf
    v_max_f32_dpp v40, v40, v40 row_ror:4 row_mask:0xf bank_mask:0xf
    v_mov_b32_dpp v96, v120 quad_perm:[0,1,2,3] row_mask:0x8 bank_mask:0xf
    v_mov_b32_dpp v100, v124 quad_perm:[0,1,2,3] row_mask:0x8 bank_mask:0xf
    v_max_f32_dpp v40, v40, v40 row_ror:2 row_mask:0xf bank_mask:0xf
    s_nop 1
    v_max_f32_dpp v40, v40, v40 row_ror:1 row_mask:0xf bank_mask:0xf
    v_mul_f32 v34, s87, v40
    v_fma_f32 v41, v96, s87, -v34
    v_fma_f32 v42, v100, s87, -v34
    v_exp_f32 v41, v41
    v_exp_f32 v42, v42
    s_nop 0
    v_cvt_pk_bf16_f32 v43, v41, v42
    ds_write_b32 v20, v43
    ds_read_b128 v[88:91], v21
    ds_read_b128 v[92:95], v21 offset:128
    ds_write_b32 v22, v34
    v_add_f32 v36, v41, v42
    s_nop 1
    v_add_f32_dpp v36, v36, v36 row_ror:8 row_mask:0xf bank_mask:0xf
    s_nop 1
    v_add_f32_dpp v36, v36, v36 row_ror:4 row_mask:0xf bank_mask:0xf
    s_nop 1
    v_add_f32_dpp v36, v36, v36 row_ror:2 row_mask:0xf bank_mask:0xf
    s_nop 1
    v_add_f32_dpp v36, v36, v36 row_ror:1 row_mask:0xf bank_mask:0xf
    s_waitcnt lgkmcnt(0)
    v_smfmac_f32_16x16x64_bf16 v[128:131], v[88:91], a[128:135], v2
    s_barrier
    ds_read_b128 v[44:47], v28 offset:2816
    v_smfmac_f32_16x16x64_bf16 v[132:135], v[88:91], a[144:151], v2
    v_add_f32_dpp v36, v36, v36 row_bcast:15 row_mask:0xa bank_mask:0xf
    v_smfmac_f32_16x16x64_bf16 v[136:139], v[88:91], a[160:167], v2
    s_nop 0
    v_add_f32_dpp v36, v36, v36 row_bcast:31 row_mask:0xc bank_mask:0xf
    v_smfmac_f32_16x16x64_bf16 v[140:143], v[88:91], a[176:183], v2
    s_waitcnt lgkmcnt(0)
    v_max3_f32 v44, v44, v45, v46
    v_smfmac_f32_16x16x64_bf16 v[144:147], v[88:91], a[192:199], v2
    v_max_f32 v44, v44, v47
    v_smfmac_f32_16x16x64_bf16 v[148:151], v[88:91], a[208:215], v2
    v_sub_f32 v35, v34, v44
    v_mov_b32 v34, v44
    v_smfmac_f32_16x16x64_bf16 v[152:155], v[88:91], a[224:231], v2
    v_exp_f32 v35, v35
    v_smfmac_f32_16x16x64_bf16 v[156:159], v[88:91], a[240:247], v2
    v_mul_f32 v36, v36, v35
    ds_write_b32 v23, v36
    s_cmp_eq_u32 s13, 1
    s_waitcnt vmcnt(17)
    s_cbranch_scc1 L_w2_62
    s_cmp_eq_u32 s13, 2
    s_waitcnt vmcnt(17)
    s_cbranch_scc1 L_w2_62
    s_waitcnt vmcnt(9)
L_w2_62:
    ds_read_b64_tr_b16 a[136:137], v232 offset:16384
    ds_read_b64_tr_b16 a[138:139], v233 offset:16384
    ds_read_b64_tr_b16 a[152:153], v234 offset:16384
    ds_read_b64_tr_b16 a[154:155], v235 offset:16384
    ds_read_b64_tr_b16 a[168:169], v236 offset:16384
    ds_read_b64_tr_b16 a[170:171], v237 offset:16384
    ds_read_b64_tr_b16 a[184:185], v238 offset:16384
    ds_read_b64_tr_b16 a[186:187], v239 offset:16384
    ds_read_b64_tr_b16 a[200:201], v240 offset:16384
    ds_read_b64_tr_b16 a[202:203], v241 offset:16384
    ds_read_b64_tr_b16 a[216:217], v242 offset:16384
    ds_read_b64_tr_b16 a[218:219], v243 offset:16384
    ds_read_b64_tr_b16 a[232:233], v244 offset:16384
    ds_read_b64_tr_b16 a[234:235], v245 offset:16384
    ds_read_b64_tr_b16 a[248:249], v246 offset:16384
    ds_read_b64_tr_b16 a[250:251], v247 offset:16384
    s_cmp_eq_u32 s13, 0
    s_cbranch_scc1 L_tr_63
    buffer_load_dwordx4 v4, s[52:55], s63 offen nt lds
    s_addk_i32 m0, 1024
    s_add_u32 s63, s63, s65
    buffer_load_dwordx4 v5, s[52:55], s63 offen nt lds
    s_addk_i32 m0, 1024
    s_add_u32 s63, s63, s65
    buffer_load_dwordx4 v4, s[52:55], s63 offen nt lds
    s_addk_i32 m0, 1024
    s_add_u32 s63, s63, s65
    buffer_load_dwordx4 v5, s[52:55], s63 offen nt lds
    s_addk_i32 m0, 1024
    s_add_u32 s63, s63, s65
    buffer_load_dwordx4 v4, s[52:55], s63 offen nt lds
    s_addk_i32 m0, 1024
    s_add_u32 s63, s63, s65
    buffer_load_dwordx4 v5, s[52:55], s63 offen nt lds
    s_addk_i32 m0, 1024
    s_add_u32 s63, s63, s65
    buffer_load_dwordx4 v4, s[52:55], s63 offen nt lds
    s_addk_i32 m0, 1024
    s_add_u32 s63, s63, s65
    buffer_load_dwordx4 v5, s[52:55], s63 offen nt lds
    s_addk_i32 m0, 1024
    s_add_u32 s63, s63, s65
L_tr_63:
    s_cmp_eq_u32 s13, 1
    s_waitcnt vmcnt(16)
    s_cbranch_scc1 L_w2_64
    s_cmp_eq_u32 s13, 2
    s_waitcnt vmcnt(16)
    s_cbranch_scc1 L_w2_64
    s_waitcnt vmcnt(0)
L_w2_64:
L_pad0_0:
    s_cbranch_execz L_pad0_1
L_walk_from:
    ds_read_b64_tr_b16 a[140:141], v232 offset:24576
    ds_read_b64_tr_b16 a[142:143], v233 offset:24576
    ds_read_b64_tr_b16 a[156:157], v234 offset:24576
    ds_read_b64_tr_b16 a[158:159], v235 offset:24576
    ds_read_b64_tr_b16 a[172:173], v236 offset:24576
    ds_read_b64_tr_b16 a[174:175], v237 offset:24576
    ds_read_b64_tr_b16 a[188:189], v238 offset:24576
    ds_read_b64_tr_b16 a[190:191], v239 offset:24576
    ds_read_b64_tr_b16 a[204:205], v240 offset:24576
    ds_read_b64_tr_b16 a[206:207], v241 offset:24576
    ds_read_b64_tr_b16 a[220:221], v242 offset:24576
    ds_read_b64_tr_b16 a[222:223], v243 offset:24576
    ds_read_b64_tr_b16 a[236:237], v244 offset:24576
    ds_read_b64_tr_b16 a[238:239], v245 offset:24576
    ds_read_b64_tr_b16 a[252:253], v246 offset:24576
    ds_read_b64_tr_b16 a[254:255], v247 offset:24576
L_fc_66:
    v_cmp_ne_u32 s[90:91], s93, v221
    s_cmp_lg_u32 s91, 0
    s_cbranch_scc1 L_fr_67
L_fk_68:
    v_cmp_ne_u32 vcc, s81, v220
    s_or_b32 s69, vcc_lo, s90
    s_cselect_b32 s66, 0, 1
    s_cmp_lg_u32 s56, 0
    s_cbranch_scc1 L_nordy
    v_mov_b32 v52, s93
    v_mov_b32 v53, s93
    v_mov_b32 v54, s93
    v_mov_b32 v55, s93
    s_cmp_eq_u32 s66, 0
    s_cbranch_scc1 L_slow_69
    buffer_store_dwordx4 v[52:55], v29, s[4:7], s15 offen
L_pubd_70:
L_nordy:
    s_waitcnt lgkmcnt(14)
    v_smfmac_f32_16x16x64_bf16 v[128:131], v[92:95], a[136:143], v2
    s_waitcnt lgkmcnt(12)
    v_smfmac_f32_16x16x64_bf16 v[132:135], v[92:95], a[152:159], v2
    s_waitcnt lgkmcnt(10)
    v_smfmac_f32_16x16x64_bf16 v[136:139], v[92:95], a[168:175], v2
    s_waitcnt lgkmcnt(8)
    v_smfmac_f32_16x16x64_bf16 v[140:143], v[92:95], a[184:191], v2
    s_waitcnt lgkmcnt(6)
    v_smfmac_f32_16x16x64_bf16 v[144:147], v[92:95], a[200:207], v2
L_pad0_1:
    s_cbranch_execz L_pad0_2
    s_waitcnt lgkmcnt(4)
    v_smfmac_f32_16x16x64_bf16 v[148:151], v[92:95], a[216:223], v2
    s_waitcnt lgkmcnt(2)
    v_smfmac_f32_16x16x64_bf16 v[152:155], v[92:95], a[232:239], v2
    s_waitcnt lgkmcnt(0)
    v_smfmac_f32_16x16x64_bf16 v[156:159], v[92:95], a[248:255], v2
    v_add_f32_dpp v48, v128, v129 quad_perm:[0,1,2,3] row_mask:0x1 bank_mask:0xf
    v_add_f32_dpp v49, v132, v133 quad_perm:[0,1,2,3] row_mask:0x1 bank_mask:0xf
    s_nop 0
    v_add_f32_dpp v48, v136, v137 quad_perm:[0,1,2,3] row_mask:0x2 bank_mask:0xf
    v_add_f32_dpp v49, v140, v141 quad_perm:[0,1,2,3] row_mask:0x2 bank_mask:0xf
    s_nop 0
    v_add_f32_dpp v48, v144, v145 quad_perm:[0,1,2,3] row_mask:0x4 bank_mask:0xf
    v_add_f32_dpp v49, v148, v149 quad_perm:[0,1,2,3] row_mask:0x4 bank_mask:0xf
    s_nop 0
    v_add_f32_dpp v48, v152, v153 quad_perm:[0,1,2,3] row_mask:0x8 bank_mask:0xf
    v_add_f32_dpp v49, v156, v157 quad_perm:[0,1,2,3] row_mask:0x8 bank_mask:0xf
    s_add_u32 s73, s93, 1
    s_and_b32 s27, s73, 0xff
L_a_end:
    v_mul_f32 v48, v48, v35
    v_mul_f32 v49, v49, v35
    ds_write2_b32 v24, v48, v49 offset0:0 offset1:16
    s_cmp_lg_u32 s56, 0
    s_waitcnt lgkmcnt(0)
    s_barrier
    s_cbranch_scc1 L_ae1_71
    ds_read_b64 v[40:41], v25 offset:0
    ds_read_b64 v[42:43], v25 offset:512
    ds_read_b64 v[44:45], v25 offset:1024
    ds_read_b64 v[46:47], v25 offset:1536
    s_cmp_eq_u32 s66, 0
    s_waitcnt lgkmcnt(2)
    v_pk_add_f32 v[40:41], v[40:41], v[42:43]
    s_waitcnt lgkmcnt(1)
    v_pk_add_f32 v[40:41], v[40:41], v[44:45]
    s_waitcnt lgkmcnt(0)
    v_pk_add_f32 v[40:41], v[40:41], v[46:47]
    v_cvt_pk_bf16_f32 v40, v40, v41
    v_min_u32 v40, -2, v40
    s_cbranch_scc1 L_slow_73
    buffer_store_dword v40, v26, s[4:7], s75 offen
L_pubd_74:
    s_branch L_aed_72
L_pad0_2:
    s_cbranch_execz L_pad0_3
L_ae1_71:
    s_cmp_lg_u32 s56, 1
    s_cbranch_scc1 L_aed_72
    ds_read_b128 v[44:47], v28 offset:2832
    v_min_u32 v40, -2, v34
    s_waitcnt lgkmcnt(0)
    v_pk_add_f32 v[44:45], v[44:45], v[46:47]
    v_add_f32 v41, v44, v45
    v_min_u32 v41, -2, v41
    s_cmp_eq_u32 s66, 0
    s_cbranch_scc1 L_slow_75
    buffer_store_dwordx2 v[40:41], v27, s[4:7], s76 offen
L_pubd_76:
L_aed_72:
L_a_done:
    s_cmp_eq_u32 s61, 1
    s_cbranch_scc1 L_od
    s_cmp_eq_u32 s61, 2
    s_cbranch_scc1 L_watch
    v_mov_b32 v96, 0
    v_mov_b32 v97, 0
    v_mov_b32 v100, 0
    v_mov_b32 v101, 0
    s_mov_b32 s12, 0
    s_cmp_lg_u32 s68, 0
    s_cbranch_scc1 L_qg_g
    s_cmp_eq_u32 s62, 0
    s_cbranch_scc1 L_qg_c
    s_cmp_lt_u32 s56, 2
    s_cbranch_scc1 L_qg_b
    s_waitcnt vmcnt(0)
L_qg_b:
    s_barrier
    ds_read_b64_tr_b16 v[192:193], v6 offset:0
    ds_read_b64_tr_b16 v[194:195], v6 offset:512
    ds_read_b64_tr_b16 v[196:197], v6 offset:4096
    ds_read_b64_tr_b16 v[198:199], v6 offset:4608
    ds_read_b64_tr_b16 v[200:201], v6 offset:8192
    ds_read_b64_tr_b16 v[202:203], v6 offset:8704
    ds_read_b64_tr_b16 v[204:205], v6 offset:12288
    ds_read_b64_tr_b16 v[206:207], v6 offset:12800
    ds_read_b64_tr_b16 v[208:209], v6 offset:32768
    ds_read_b64_tr_b16 v[210:211], v6 offset:33280
    ds_read_b64_tr_b16 v[212:213], v6 offset:36864
    ds_read_b64_tr_b16 v[214:215], v6 offset:37376
    ds_read_b64_tr_b16 v[216:217], v6 offset:40960
    ds_read_b64_tr_b16 v[218:219], v6 offset:41472
    ds_read_b64_tr_b16 v[220:221], v6 offset:45056
    ds_read_b64_tr_b16 v[222:223], v6 offset:45568
    v_mov_b32 v88, 0x3f803f80
L_pad0_3:
    s_cbranch_execz L_pad0_4
    v_mov_b32 v89, 0x3f803f80
    v_mov_b32 v90, 0x3f803f80
    v_mov_b32 v91, 0x3f803f80
    v_mov_b32 v104, 0
    v_mov_b32 v105, 0
    v_mov_b32 v108, 0
    v_mov_b32 v109, 0
    s_waitcnt lgkmcnt(0)
    v_smfmac_f32_16x16x64_bf16 v[104:107], v[88:91], v[192:199], v2
    v_smfmac_f32_16x16x64_bf16 v[108:111], v[88:91], v[208:215], v2
    v_smfmac_f32_16x16x64_bf16 v[104:107], v[88:91], v[200:207], v2
    v_smfmac_f32_16x16x64_bf16 v[108:111], v[88:91], v[216:223], v2
    s_nop 6
    v_add_f32 v40, v104, v105
    v_add_f32 v41, v108, v109
    v_bfi_b32 v40, v0, s93, v40
    v_bfi_b32 v41, v0, s93, v41
    s_lshl_b32 s70, s58, 2
    s_add_u32 s70, s70, s56
    s_mul_i32 s70, s70, 5
    s_add_u32 s70, s70, s59
    s_lshl_b32 s70, s70, 7
    s_add_u32 s70, s70, 72704
    v_lshlrev_b32 v54, 3, v1
    v_mov_b32 v44, v40
    v_mov_b32 v45, v41
    v_mov_b32_dpp v46, v40 quad_perm:[1,1,3,3] row_mask:0xf bank_mask:0xf
    v_mov_b32_dpp v47, v41 quad_perm:[1,1,3,3] row_mask:0xf bank_mask:0xf
    s_mov_b64 exec, 0x5555
    s_cmp_eq_u32 s66, 0
    s_cbranch_scc1 L_slow_77
    buffer_store_dwordx4 v[44:47], v54, s[4:7], s70 offen
L_pubd_78:
    s_mov_b64 exec, -1
L_qg_c:
    buffer_load_dwordx2 v[72:73], v14, s[4:7], 0 offen sc1
    v_bfi_b32 v32, v0, s93, v32
    v_bfi_b32 v33, v0, s93, v33
    s_lshl_b32 s70, s58, 2
    s_add_u32 s70, s70, s56
    s_mul_i32 s70, s70, 5
    s_add_u32 s70, s70, s59
    s_lshl_b32 s70, s70, 7
    s_add_u32 s70, s70, 62464
    v_lshlrev_b32 v54, 3, v1
    v_mov_b32 v48, v32
    v_mov_b32 v49, v33
    v_mov_b32_dpp v50, v32 quad_perm:[1,1,3,3] row_mask:0xf bank_mask:0xf
L_pad0_4:
    s_cbranch_execz L_pad0_5
    v_mov_b32_dpp v51, v33 quad_perm:[1,1,3,3] row_mask:0xf bank_mask:0xf
    s_mov_b64 exec, 0x5555
    s_cmp_eq_u32 s66, 0
    s_cbranch_scc1 L_slow_79
    buffer_store_dwordx4 v[48:51], v54, s[4:7], s70 offen
L_pubd_80:
    s_mov_b64 exec, -1
    v_and_b32 v54, 15, v1
    v_lshlrev_b32 v54, 3, v54
    s_mul_i32 s70, s58, 2560
    s_add_u32 s70, s70, 72704
    s_mul_i32 s71, s59, 640
    s_add_u32 s70, s70, s71
    s_mul_i32 s12, s70, s62
    s_cmp_eq_u32 s59, 4
    s_cselect_b32 s12, 0, s12
    s_cmp_eq_u32 s56, 1
    s_cbranch_scc1 L_qg_g
L_csl:
    s_cmp_eq_u32 s12, 0
    s_cbranch_scc1 L_qg_g
    s_brev_b32 exec_hi, 1
    s_mov_b32 exec_lo, 0
    buffer_load_dword v74, v248, s[48:51], s92 offen sc1
    s_mov_b64 exec, -1
    buffer_load_dwordx2 v[128:129], v54, s[4:7], s12 offen offset:0 sc1
    buffer_load_dwordx2 v[130:131], v54, s[4:7], s12 offen offset:128 sc1
    buffer_load_dwordx2 v[132:133], v54, s[4:7], s12 offen offset:256 sc1
    buffer_load_dwordx2 v[134:135], v54, s[4:7], s12 offen offset:384 sc1
    buffer_load_dwordx2 v[136:137], v54, s[4:7], s12 offen offset:512 sc1
L_pad0_5:
    s_cbranch_execz L_pad0_6
    s_waitcnt vmcnt(3)
    v_xor_b32 v128, s26, v128
    v_xor_b32 v129, s26, v129
    v_xor_b32 v130, s26, v130
    v_xor_b32 v131, s26, v131
    v_pk_add_f32 v[246:247], v[128:129], v[130:131]
    v_or3_b32 v52, v128, v129, v130
    s_waitcnt vmcnt(2)
    v_xor_b32 v132, s26, v132
    v_xor_b32 v133, s26, v133
    v_pk_add_f32 v[246:247], v[246:247], v[132:133]
    v_or3_b32 v52, v52, v131, v132
    s_waitcnt vmcnt(1)
    v_xor_b32 v134, s26, v134
    v_xor_b32 v135, s26, v135
    v_pk_add_f32 v[246:247], v[246:247], v[134:135]
    v_or3_b32 v52, v52, v133, v134
    s_waitcnt vmcnt(0)
    v_xor_b32 v136, s26, v136
    v_xor_b32 v137, s26, v137
    v_or3_b32 v52, v52, v135, v136
    v_pk_add_f32 v[246:247], v[246:247], v[136:137]
    v_bitop3_b32 v52, v52, v137, v0 bitop3:0xa8
    v_cmp_ne_u32 vcc, 0, v52
    v_readlane_b32 s70, v74, 63
    s_xor_b32 s70, s70, s93
    s_andn2_b32 s72, s70, 0x2000
    s_cselect_b32 s3, s3, s70
    s_cselect_b32 s19, s19, 1
    s_cmp_lg_u64 vcc, 0
    s_cselect_b32 s12, s12, 0
    s_add_u32 s67, s67, 1
    s_cmp_lt_u32 s67, 1048576
    s_cbranch_scc1 L_csl
L_qg_g:
    s_add_u32 s69, s92, s3
    s_add_u32 s71, s77, s3
    s_cmp_lg_u32 s56, s19
    s_cbranch_scc1 L_hk_85
L_hl_84:
    buffer_load_dword v72, v248, s[48:51], s69 offen sc1
L_pad0_6:
    s_cbranch_execz L_pad0_7
    s_waitcnt vmcnt(0)
    v_cmp_ne_u32 vcc, s93, v72
    s_cmp_eq_u32 vcc_lo, 0
    s_cbranch_scc1 L_hk_85
    v_readlane_b32 s70, v72, 63
    s_add_u32 s67, s67, 1
    s_xor_b32 s70, s70, s93
    s_andn2_b32 s72, s70, 0x2000
    s_cselect_b32 s3, s3, s70
    s_cselect_b32 s19, s19, 1
    s_add_u32 s69, s92, s3
    s_add_u32 s71, s77, s3
    s_cmp_lg_u32 s56, s19
    s_cbranch_scc1 L_hk_85
    s_cmp_lt_u32 s67, 1048576
    s_cbranch_scc1 L_hl_84
L_hk_85:
    s_barrier
    s_cmp_eq_u32 s12, 0
    s_cbranch_scc1 L_nocs1
    buffer_load_dwordx2 v[128:129], v54, s[4:7], s12 offen offset:0 sc1
    buffer_load_dwordx2 v[130:131], v54, s[4:7], s12 offen offset:128 sc1
    buffer_load_dwordx2 v[132:133], v54, s[4:7], s12 offen offset:256 sc1
    buffer_load_dwordx2 v[134:135], v54, s[4:7], s12 offen offset:384 sc1
    buffer_load_dwordx2 v[136:137], v54, s[4:7], s12 offen offset:512 sc1
L_nocs1:
L_xg_81:
    buffer_load_dwordx4 v[56:59], v10, s[48:51], s71 offen offset:0 sc1
    buffer_load_dwordx4 v[60:63], v10, s[48:51], s71 offen offset:1024 sc1
    buffer_load_dwordx4 v[64:67], v10, s[48:51], s71 offen offset:2048 sc1
    buffer_load_dwordx4 v[68:71], v10, s[48:51], s71 offen offset:3072 sc1
    s_cmp_lt_u32 s12, 2
    s_cbranch_scc1 L_nocs3
    s_waitcnt vmcnt(4)
    v_xor_b32 v128, s26, v128
    v_xor_b32 v129, s26, v129
    v_xor_b32 v130, s26, v130
    v_xor_b32 v131, s26, v131
    v_pk_add_f32 v[246:247], v[128:129], v[130:131]
    v_or3_b32 v52, v128, v129, v130
    v_xor_b32 v132, s26, v132
    v_xor_b32 v133, s26, v133
    v_pk_add_f32 v[246:247], v[246:247], v[132:133]
    v_or3_b32 v52, v52, v131, v132
    v_xor_b32 v134, s26, v134
    v_xor_b32 v135, s26, v135
    v_pk_add_f32 v[246:247], v[246:247], v[134:135]
    v_or3_b32 v52, v52, v133, v134
    v_xor_b32 v136, s26, v136
L_pad0_7:
    s_cbranch_execz L_pad0_8
    v_xor_b32 v137, s26, v137
    v_or3_b32 v52, v52, v135, v136
    v_pk_add_f32 v[246:247], v[246:247], v[136:137]
    v_bitop3_b32 v52, v52, v137, v0 bitop3:0xa8
    v_cmp_ne_u32 vcc, 0, v52
    s_cmp_lg_u64 vcc, 0
    s_cselect_b32 s12, 1, 0
L_nocs3:
    s_waitcnt vmcnt(3)
    v_xor_b32 v56, s26, v56
    v_xor_b32 v57, s26, v57
    v_xor_b32 v58, s26, v58
    v_xor_b32 v59, s26, v59
    s_waitcnt vmcnt(2)
    v_xor_b32 v60, s26, v60
    v_xor_b32 v61, s26, v61
    v_xor_b32 v62, s26, v62
    v_xor_b32 v63, s26, v63
    v_pk_add_f32 v[40:41], v[56:57], v[60:61]
    v_pk_add_f32 v[42:43], v[58:59], v[62:63]
    v_or3_b32 v44, v56, v57, v58
    v_or3_b32 v44, v44, v59, v60
    v_or3_b32 v44, v44, v61, v62
    s_waitcnt vmcnt(1)
    v_xor_b32 v64, s26, v64
    v_xor_b32 v65, s26, v65
    v_xor_b32 v66, s26, v66
    v_xor_b32 v67, s26, v67
    v_pk_add_f32 v[40:41], v[40:41], v[64:65]
    v_pk_add_f32 v[42:43], v[42:43], v[66:67]
    v_or3_b32 v44, v44, v63, v64
    v_or3_b32 v44, v44, v65, v66
    s_waitcnt vmcnt(0)
    v_xor_b32 v68, s26, v68
    v_xor_b32 v69, s26, v69
    v_xor_b32 v70, s26, v70
    v_xor_b32 v71, s26, v71
    v_pk_add_f32 v[40:41], v[40:41], v[68:69]
    v_pk_add_f32 v[42:43], v[42:43], v[70:71]
    v_or3_b32 v44, v44, v67, v68
    v_or3_b32 v44, v44, v69, v70
    v_permlane32_swap_b32 v40, v42
    v_permlane32_swap_b32 v41, v43
    v_bitop3_b32 v44, v44, v71, v0 bitop3:0xa8
    v_pk_add_f32 v[40:41], v[40:41], v[42:43]
    v_cmp_ne_u32 vcc, 0, v44
    v_pk_add_f32 v[40:41], v[40:41], v[30:31]
L_pad0_8:
    s_cbranch_execz L_pad0_9
    v_cvt_pk_bf16_f32 v37, v40, v41
    s_cbranch_vccnz L_xgr_82
L_xgk_83:
    s_add_u32 s92, s92, 32768
    s_cmp_eq_u32 s62, 0
    s_cbranch_scc1 L_ng_86
    ds_write_b32 v11, v37
    v_lshlrev_b32 v30, 16, v37
    v_and_b32 v31, 0xffff0000, v37
    v_add_f32 v44, v30, v31
    v_mul_f32 v45, v30, v30
    v_fmac_f32 v45, v31, v31
    s_nop 1
    v_permlane32_swap_b32 v44, v45
    v_add_f32 v44, v44, v45
    v_mov_b32 v45, s73
    s_nop 0
    v_add_f32_dpp v44, v44, v44 row_ror:8 row_mask:0xf bank_mask:0xf
    s_waitcnt lgkmcnt(0)
    s_barrier
    ds_read_b128 v[88:91], v12
    ds_read_b128 v[92:95], v12 offset:128
    v_add_f32_dpp v44, v44, v44 row_ror:4 row_mask:0xf bank_mask:0xf
    s_nop 1
    v_add_f32_dpp v44, v44, v44 row_ror:2 row_mask:0xf bank_mask:0xf
    s_nop 1
    v_add_f32_dpp v44, v44, v44 row_ror:1 row_mask:0xf bank_mask:0xf
    s_nop 1
    v_add_f32_dpp v44, v44, v44 row_bcast:15 row_mask:0xa bank_mask:0xf
    s_cmp_eq_u32 s66, 0
    s_cbranch_scc1 L_slow_87
    buffer_store_dwordx2 v[44:45], v15, s[4:7], 0 offen
L_pubd_88:
    s_waitcnt lgkmcnt(1)
    v_smfmac_f32_16x16x64_bf16 v[96:99], v[88:91], v[192:199], v2
    v_smfmac_f32_16x16x64_bf16 v[100:103], v[88:91], v[208:215], v2
    s_waitcnt lgkmcnt(0)
    v_smfmac_f32_16x16x64_bf16 v[96:99], v[92:95], v[200:207], v2
L_pad0_9:
    s_cbranch_execz L_pad0_10
    v_smfmac_f32_16x16x64_bf16 v[100:103], v[92:95], v[216:223], v2
    s_nop 6
    v_add_f32 v40, v96, v97
    v_add_f32 v41, v100, v101
    v_bfi_b32 v40, v0, s73, v40
    v_bfi_b32 v41, v0, s73, v41
    s_cbranch_scc1 L_slow_89
    buffer_store_dwordx2 v[40:41], v13, s[4:7], s80 offen
L_pubd_90:
    s_add_u32 s15, s15, 512
    v_mov_b32 v52, s93
    s_cmp_eq_u32 s66, 0
    s_cbranch_scc1 L_slow_91
    buffer_store_dword v52, v29, s[4:7], s15 offen offset:0
L_pubd_92:
    s_cmp_eq_u32 s59, 4
    s_cbranch_scc1 L_qg_h_done
    s_cmp_lg_u32 s12, 0
    s_cbranch_scc1 L_qg_cs
L_qg_h:
    s_or_b32 s69, s56, s68
    s_cbranch_scc0 L_qg_h_done
    s_cmp_lt_u32 s10, 1
    s_cbranch_scc1 L_hgo
    s_nop 15
    s_cmp_lt_u32 s10, 2
    s_cbranch_scc1 L_hgo
    s_nop 15
    s_cmp_lt_u32 s10, 3
    s_cbranch_scc1 L_hgo
    s_nop 15
L_hgo:
    s_nop 15
L_r5_93:
    buffer_load_dwordx2 v[66:67], v14, s[4:7], 0 offen sc1
    buffer_load_dwordx2 v[56:57], v255, s[4:7], s80 offen offset:0 sc1
    buffer_load_dwordx2 v[58:59], v255, s[4:7], s80 offen offset:128 sc1
    buffer_load_dwordx2 v[60:61], v255, s[4:7], s80 offen offset:256 sc1
    buffer_load_dwordx2 v[62:63], v255, s[4:7], s80 offen offset:384 sc1
    buffer_load_dwordx2 v[64:65], v255, s[4:7], s80 offen offset:512 sc1
    ds_read_b32 v53, v28 offset:2848
L_pad0_10:
    s_cbranch_execz L_pad0_11
    s_waitcnt vmcnt(5)
    v_cmp_ne_u32 vcc, s73, v67
    v_add_f32_dpp v48, v66, v66 quad_perm:[1,0,3,2] row_mask:0xf bank_mask:0xf
    s_and_b64 vcc, vcc, s[8:9]
    s_cbranch_scc1 L_r5r_94
    s_waitcnt vmcnt(3)
    v_xor_b32 v56, s27, v56
    v_xor_b32 v57, s27, v57
    v_add_f32_dpp v48, v48, v48 quad_perm:[2,3,0,1] row_mask:0xf bank_mask:0xf
    v_xor_b32 v58, s27, v58
    v_xor_b32 v59, s27, v59
    v_add_f32_dpp v48, v48, v48 row_half_mirror row_mask:0xf bank_mask:0xf
    v_mul_f32 v48, s85, v48
    v_pk_add_f32 v[40:41], v[56:57], v[58:59]
    v_or3_b32 v52, v56, v57, v58
    v_mov_b32_dpp v49, v48 row_newbcast:8 row_mask:0xf bank_mask:0xf
    v_mov_b32_dpp v48, v48 row_newbcast:0 row_mask:0xf bank_mask:0xf
    s_waitcnt vmcnt(2)
    v_xor_b32 v60, s27, v60
    v_xor_b32 v61, s27, v61
    v_fma_f32 v50, -v48, v48, v49
    v_pk_fma_f32 v[40:41], v[246:247], v[48:49], v[40:41] op_sel_hi:[1,0,1] neg_lo:[0,1,0] neg_hi:[0,1,0]
    v_pk_add_f32 v[40:41], v[40:41], v[60:61]
    v_or3_b32 v52, v52, v59, v60
    v_max_f32 v50, 0, v50
    s_waitcnt vmcnt(1)
    v_xor_b32 v62, s27, v62
    v_xor_b32 v63, s27, v63
    v_add_f32 v50, s86, v50
    v_pk_add_f32 v[40:41], v[40:41], v[62:63]
    v_or3_b32 v52, v52, v61, v62
    v_rcp_f32 v50, v50
    s_waitcnt vmcnt(0)
    v_xor_b32 v64, s27, v64
    v_xor_b32 v65, s27, v65
    v_or3_b32 v52, v52, v63, v64
    v_pk_add_f32 v[40:41], v[40:41], v[64:65]
    v_bitop3_b32 v52, v52, v65, v0 bitop3:0xa8
    v_cmp_ne_u32 vcc, 0, v52
    v_max_f32 v40, 0, v40
    v_mul_f32 v41, v41, v50
    v_mul_f32 v40, v40, v41
    s_cbranch_vccnz L_r5r_94
L_r5k_95:
    s_cmp_eq_u32 s66, 0
    v_mov_b32_dpp v41, v40 quad_perm:[1,1,3,3] row_mask:0xf bank_mask:0xf
    v_cvt_pk_bf16_f32 v40, v40, v41
L_pad0_11:
    s_cbranch_execz L_walk_back
    v_min_u32 v40, -2, v40
    s_cbranch_scc1 L_slow_97
    buffer_store_dword v40, v249, s[4:7], s79 offen
L_pubd_98:
    s_add_u32 s69, s68, 1
    v_mov_b32 v54, s69
    ds_write_b32 v28, v54 offset:2848
L_qg_h_done:
    s_cmp_lg_u32 s68, 0
    s_cbranch_scc1 L_final
    v_mov_b32 v96, 0
    v_mov_b32 v97, 0
    v_mov_b32 v100, 0
    v_mov_b32 v101, 0
    s_add_u32 s73, s93, 2
    s_and_b32 s27, s73, 0xff
    s_cmp_lg_u32 s56, 0
    s_cbranch_scc1 L_qg_q
    v_and_b32 v54, 15, v1
    v_lshlrev_b32 v54, 3, v54
    s_mul_i32 s70, s58, 2560
    s_add_u32 s70, s70, 62464
    v_lshrrev_b32 v55, 4, v1
    v_mul_u32_u24 v55, 640, v55
    v_add_u32 v54, v54, v55
L_cs_99:
    buffer_load_dwordx2 v[56:57], v54, s[4:7], s70 offen offset:0 sc1
    buffer_load_dwordx2 v[58:59], v54, s[4:7], s70 offen offset:128 sc1
    buffer_load_dwordx2 v[60:61], v54, s[4:7], s70 offen offset:256 sc1
    buffer_load_dwordx2 v[62:63], v54, s[4:7], s70 offen offset:384 sc1
    buffer_load_dwordx2 v[64:65], v54, s[4:7], s70 offen offset:512 sc1
L_pad1_0:
    s_cbranch_execz L_pad1_1
    s_waitcnt vmcnt(3)
    v_xor_b32 v56, s26, v56
    v_xor_b32 v57, s26, v57
    v_xor_b32 v58, s26, v58
    v_xor_b32 v59, s26, v59
    v_pk_add_f32 v[32:33], v[56:57], v[58:59]
    v_or3_b32 v52, v56, v57, v58
    s_waitcnt vmcnt(2)
    v_xor_b32 v60, s26, v60
    v_xor_b32 v61, s26, v61
    v_pk_add_f32 v[32:33], v[32:33], v[60:61]
    v_or3_b32 v52, v52, v59, v60
    s_waitcnt vmcnt(1)
    v_xor_b32 v62, s26, v62
    v_xor_b32 v63, s26, v63
    v_pk_add_f32 v[32:33], v[32:33], v[62:63]
    v_or3_b32 v52, v52, v61, v62
    s_waitcnt vmcnt(0)
    v_xor_b32 v64, s26, v64
    v_xor_b32 v65, s26, v65
    v_or3_b32 v52, v52, v63, v64
    v_pk_add_f32 v[32:33], v[32:33], v[64:65]
    v_bitop3_b32 v52, v52, v65, v0 bitop3:0xa8
    v_cmp_ne_u32 vcc, 0, v52
    s_cbranch_vccnz L_csr_100
L_csk_101:
L_qg_q:
    s_mov_b32 s19, s56
    s_mov_b32 s75, 8192
    s_mov_b32 s76, 20992
    s_mov_b32 s77, 1081344
    s_mov_b32 s79, 18432
    s_mov_b32 s15, 86016
    v_mov_b32 v104, 0
    v_mov_b32 v105, 0
    v_mov_b32 v108, 0
    v_mov_b32 v109, 0
    v_mov_b32 v112, 0
    v_mov_b32 v113, 0
    v_mov_b32 v116, 0
    v_mov_b32 v117, 0
    v_mov_b32 v120, 0
    v_mov_b32 v121, 0
    v_mov_b32 v124, 0
    v_mov_b32 v125, 0
    v_mov_b32 v128, 0
    v_mov_b32 v129, 0
    v_mov_b32 v132, 0
    v_mov_b32 v133, 0
    v_mov_b32 v136, 0
    v_mov_b32 v137, 0
    v_mov_b32 v140, 0
L_pad1_1:
    s_cbranch_execz L_pad1_2
    v_mov_b32 v141, 0
    v_mov_b32 v144, 0
    v_mov_b32 v145, 0
    v_mov_b32 v148, 0
    v_mov_b32 v149, 0
    v_mov_b32 v152, 0
    v_mov_b32 v153, 0
    v_mov_b32 v156, 0
    v_mov_b32 v157, 0
    s_add_u32 s69, s92, s3
    s_add_u32 s71, s78, s3
    s_cmp_lg_u32 s56, s19
    s_cbranch_scc1 L_hk_106
L_hl_105:
    buffer_load_dword v72, v248, s[48:51], s69 offen sc1
    s_waitcnt vmcnt(0)
    v_cmp_ne_u32 vcc, s93, v72
    s_cmp_eq_u32 vcc_lo, 0
    s_cbranch_scc1 L_hk_106
    v_readlane_b32 s70, v72, 63
    s_add_u32 s67, s67, 1
    s_xor_b32 s70, s70, s93
    s_andn2_b32 s72, s70, 0x2000
    s_cselect_b32 s3, s3, s70
    s_cselect_b32 s19, s19, 1
    s_add_u32 s69, s92, s3
    s_add_u32 s71, s78, s3
    s_cmp_lg_u32 s56, s19
    s_cbranch_scc1 L_hk_106
    s_cmp_lt_u32 s67, 1048576
    s_cbranch_scc1 L_hl_105
L_hk_106:
    s_barrier
L_xg_102:
    buffer_load_dwordx4 v[56:59], v10, s[48:51], s71 offen offset:0 sc1
    buffer_load_dwordx4 v[60:63], v10, s[48:51], s71 offen offset:1024 sc1
    buffer_load_dwordx4 v[64:67], v10, s[48:51], s71 offen offset:2048 sc1
    buffer_load_dwordx4 v[68:71], v10, s[48:51], s71 offen offset:3072 sc1
L_pad1_2:
    s_cbranch_execz L_pad1_3
    s_waitcnt vmcnt(3)
    v_xor_b32 v56, s26, v56
    v_xor_b32 v57, s26, v57
    v_xor_b32 v58, s26, v58
    v_xor_b32 v59, s26, v59
    s_waitcnt vmcnt(2)
    v_xor_b32 v60, s26, v60
    v_xor_b32 v61, s26, v61
    v_xor_b32 v62, s26, v62
    v_xor_b32 v63, s26, v63
    v_pk_add_f32 v[40:41], v[56:57], v[60:61]
    v_pk_add_f32 v[42:43], v[58:59], v[62:63]
    v_or3_b32 v44, v56, v57, v58
    v_or3_b32 v44, v44, v59, v60
    v_or3_b32 v44, v44, v61, v62
    s_waitcnt vmcnt(1)
    v_xor_b32 v64, s26, v64
    v_xor_b32 v65, s26, v65
    v_xor_b32 v66, s26, v66
    v_xor_b32 v67, s26, v67
    v_pk_add_f32 v[40:41], v[40:41], v[64:65]
    v_pk_add_f32 v[42:43], v[42:43], v[66:67]
    v_or3_b32 v44, v44, v63, v64
    v_or3_b32 v44, v44, v65, v66
    s_waitcnt vmcnt(0)
    v_xor_b32 v68, s26, v68
    v_xor_b32 v69, s26, v69
    v_xor_b32 v70, s26, v70
    v_xor_b32 v71, s26, v71
    v_pk_add_f32 v[40:41], v[40:41], v[68:69]
    v_pk_add_f32 v[42:43], v[42:43], v[70:71]
    v_or3_b32 v44, v44, v67, v68
    v_or3_b32 v44, v44, v69, v70
    v_permlane32_swap_b32 v40, v42
    v_permlane32_swap_b32 v41, v43
    v_bitop3_b32 v44, v44, v71, v0 bitop3:0xa8
    v_pk_add_f32 v[40:41], v[40:41], v[42:43]
    v_cmp_ne_u32 vcc, 0, v44
    v_pk_add_f32 v[40:41], v[40:41], v[30:31]
    v_cvt_pk_bf16_f32 v37, v40, v41
    s_cbranch_vccnz L_xgr_103
L_xgk_104:
    s_add_u32 s92, s92, 32768
    ds_write_b32 v11, v37
    v_lshlrev_b32 v30, 16, v37
    v_and_b32 v31, 0xffff0000, v37
L_pad1_3:
    s_cbranch_execz L_pad1_4
    v_add_f32 v44, v30, v31
    v_mul_f32 v45, v30, v30
    v_fmac_f32 v45, v31, v31
    s_nop 1
    v_permlane32_swap_b32 v44, v45
    v_add_f32 v44, v44, v45
    v_mov_b32 v45, s73
    s_nop 0
    v_add_f32_dpp v44, v44, v44 row_ror:8 row_mask:0xf bank_mask:0xf
    s_waitcnt lgkmcnt(0)
    s_barrier
    ds_read_b128 v[88:91], v12
    ds_read_b128 v[92:95], v12 offset:128
    v_add_f32_dpp v44, v44, v44 row_ror:4 row_mask:0xf bank_mask:0xf
    s_nop 1
    v_add_f32_dpp v44, v44, v44 row_ror:2 row_mask:0xf bank_mask:0xf
    s_nop 1
    v_add_f32_dpp v44, v44, v44 row_ror:1 row_mask:0xf bank_mask:0xf
    s_nop 1
    v_add_f32_dpp v44, v44, v44 row_bcast:15 row_mask:0xa bank_mask:0xf
    s_cmp_eq_u32 s66, 0
    s_cbranch_scc1 L_slow_107
    buffer_store_dwordx2 v[44:45], v15, s[4:7], 0 offen
L_pubd_108:
    s_waitcnt lgkmcnt(1)
    v_smfmac_f32_16x16x64_bf16 v[96:99], v[88:91], v[160:167], v2
    v_smfmac_f32_16x16x64_bf16 v[100:103], v[88:91], v[176:183], v2
    s_waitcnt lgkmcnt(0)
    v_smfmac_f32_16x16x64_bf16 v[96:99], v[92:95], v[168:175], v2
    v_smfmac_f32_16x16x64_bf16 v[100:103], v[92:95], v[184:191], v2
    s_nop 6
    v_add_f32 v40, v96, v97
    v_add_f32 v41, v100, v101
    v_bfi_b32 v40, v0, s73, v40
    v_bfi_b32 v41, v0, s73, v41
    s_cbranch_scc1 L_slow_109
    buffer_store_dwordx2 v[40:41], v13, s[4:7], s80 offen
L_pubd_110:
    s_branch L_att2
L_pad1_4:
    s_branch L_pad1_5
L_next:
    s_cmp_lg_u32 s68, 0
    s_cbranch_scc1 L_end_prof
    s_add_u32 s73, s93, 2
    s_and_b32 s27, s73, 0xff
    s_cmp_lg_u32 s56, 0
    s_cbranch_scc1 L_next2
    v_and_b32 v54, 15, v1
    v_lshlrev_b32 v54, 3, v54
    s_mul_i32 s70, s58, 2560
    s_add_u32 s70, s70, 62464
    v_lshrrev_b32 v55, 4, v1
    v_mul_u32_u24 v55, 640, v55
    v_add_u32 v54, v54, v55
L_cs_111:
    buffer_load_dwordx2 v[56:57], v54, s[4:7], s70 offen offset:0 sc1
    buffer_load_dwordx2 v[58:59], v54, s[4:7], s70 offen offset:128 sc1
    buffer_load_dwordx2 v[60:61], v54, s[4:7], s70 offen offset:256 sc1
    buffer_load_dwordx2 v[62:63], v54, s[4:7], s70 offen offset:384 sc1
    buffer_load_dwordx2 v[64:65], v54, s[4:7], s70 offen offset:512 sc1
    s_waitcnt vmcnt(3)
    v_xor_b32 v56, s26, v56
    v_xor_b32 v57, s26, v57
    v_xor_b32 v58, s26, v58
    v_xor_b32 v59, s26, v59
    v_pk_add_f32 v[32:33], v[56:57], v[58:59]
    v_or3_b32 v52, v56, v57, v58
    s_waitcnt vmcnt(2)
    v_xor_b32 v60, s26, v60
    v_xor_b32 v61, s26, v61
    v_pk_add_f32 v[32:33], v[32:33], v[60:61]
    v_or3_b32 v52, v52, v59, v60
    s_waitcnt vmcnt(1)
    v_xor_b32 v62, s26, v62
    v_xor_b32 v63, s26, v63
    v_pk_add_f32 v[32:33], v[32:33], v[62:63]
    v_or3_b32 v52, v52, v61, v62
    s_waitcnt vmcnt(0)
    v_xor_b32 v64, s26, v64
    v_xor_b32 v65, s26, v65
    v_or3_b32 v52, v52, v63, v64
    v_pk_add_f32 v[32:33], v[32:33], v[64:65]
    v_bitop3_b32 v52, v52, v65, v0 bitop3:0xa8
    v_cmp_ne_u32 vcc, 0, v52
    s_cbranch_vccnz L_csr_112
L_csk_113:
L_next2:
    s_mov_b32 s75, 8192
    s_mov_b32 s76, 20992
L_pad1_5:
    s_cbranch_execz L_pad1_6
    s_mov_b32 s77, 1081344
    s_mov_b32 s79, 18432
    s_mov_b32 s15, 86016
    v_mov_b32 v104, 0
    v_mov_b32 v105, 0
    v_mov_b32 v108, 0
    v_mov_b32 v109, 0
    v_mov_b32 v112, 0
    v_mov_b32 v113, 0
    v_mov_b32 v116, 0
    v_mov_b32 v117, 0
    v_mov_b32 v120, 0
    v_mov_b32 v121, 0
    v_mov_b32 v124, 0
    v_mov_b32 v125, 0
    v_mov_b32 v128, 0
    v_mov_b32 v129, 0
    v_mov_b32 v132, 0
    v_mov_b32 v133, 0
    v_mov_b32 v136, 0
    v_mov_b32 v137, 0
    v_mov_b32 v140, 0
    v_mov_b32 v141, 0
    v_mov_b32 v144, 0
    v_mov_b32 v145, 0
    v_mov_b32 v148, 0
    v_mov_b32 v149, 0
    v_mov_b32 v152, 0
    v_mov_b32 v153, 0
    v_mov_b32 v156, 0
    v_mov_b32 v157, 0
    s_cmp_lg_u32 s61, 1
    s_cbranch_scc1 L_wl
    buffer_load_dwordx4 v[88:91], v11, s[4:7], s76 offen sc1
    buffer_load_dwordx4 v[88:91], v10, s[4:7], s75 offen sc1
    buffer_load_dwordx4 v[88:91], v10, s[4:7], s75 offen offset:1024 sc1
    v_lshlrev_b32 v55, 4, v1
    buffer_load_dwordx4 v[88:91], v55, s[4:7], s15 offen sc1
L_pad1_6:
    s_cbranch_execz L_pad1_7
    s_waitcnt vmcnt(0)
L_wl:
    s_sleep 6
    s_cmp_lg_u32 s56, 0
    s_cbranch_scc1 L_att2
L_gate:
    buffer_load_dwordx2 v[56:57], v17, s[4:7], 0 offen sc1
    s_add_u32 s67, s67, 1
    s_cmp_ge_u32 s67, 1048576
    s_cbranch_scc1 L_att2
    s_waitcnt vmcnt(0)
    v_cmp_eq_u32 vcc, s73, v57
    s_and_b64 vcc, vcc, s[8:9]
    s_cbranch_scc0 L_gate
L_att2:
    s_mov_b32 s68, 1
    s_mov_b32 s78, 1245184
    v_mov_b32 v96, 0
    v_mov_b32 v97, 0
    v_mov_b32 v100, 0
    v_mov_b32 v101, 0
    s_cmp_lg_u32 s56, 0
    s_cbranch_scc1 L_ai_j_114
    s_nop 15
    buffer_load_dwordx2 v[66:67], v17, s[4:7], 0 offen sc1
    buffer_load_dwordx2 v[56:57], v16, s[4:7], s80 offen offset:0 sc1
    buffer_load_dwordx2 v[58:59], v16, s[4:7], s80 offen offset:128 sc1
    buffer_load_dwordx2 v[60:61], v16, s[4:7], s80 offen offset:256 sc1
    buffer_load_dwordx2 v[62:63], v16, s[4:7], s80 offen offset:384 sc1
    buffer_load_dwordx2 v[64:65], v16, s[4:7], s80 offen offset:512 sc1
    s_nop 15
    s_nop 15
    s_nop 15
    buffer_load_dwordx2 v[78:79], v17, s[4:7], 0 offen sc1
    buffer_load_dwordx2 v[68:69], v16, s[4:7], s80 offen offset:0 sc1
    buffer_load_dwordx2 v[70:71], v16, s[4:7], s80 offen offset:128 sc1
    buffer_load_dwordx2 v[72:73], v16, s[4:7], s80 offen offset:256 sc1
    buffer_load_dwordx2 v[74:75], v16, s[4:7], s80 offen offset:384 sc1
    buffer_load_dwordx2 v[76:77], v16, s[4:7], s80 offen offset:512 sc1
L_ap_115:
    s_waitcnt vmcnt(11)
    v_cmp_ne_u32 vcc, s73, v67
    v_add_f32_dpp v48, v66, v66 quad_perm:[1,0,3,2] row_mask:0xf bank_mask:0xf
    s_and_b64 vcc, vcc, s[8:9]
    s_cbranch_scc1 L_af_117
    s_waitcnt vmcnt(9)
    v_xor_b32 v56, s27, v56
    v_xor_b32 v57, s27, v57
    v_add_f32_dpp v48, v48, v48 quad_perm:[2,3,0,1] row_mask:0xf bank_mask:0xf
    v_xor_b32 v58, s27, v58
    v_xor_b32 v59, s27, v59
L_pad1_7:
    s_cbranch_execz L_pad1_8
    v_add_f32_dpp v48, v48, v48 row_half_mirror row_mask:0xf bank_mask:0xf
    v_mul_f32 v48, s85, v48
    v_pk_add_f32 v[40:41], v[56:57], v[58:59]
    v_or3_b32 v52, v56, v57, v58
    v_mov_b32_dpp v49, v48 row_newbcast:8 row_mask:0xf bank_mask:0xf
    v_mov_b32_dpp v48, v48 row_newbcast:0 row_mask:0xf bank_mask:0xf
    s_waitcnt vmcnt(8)
    v_xor_b32 v60, s27, v60
    v_xor_b32 v61, s27, v61
    v_fma_f32 v50, -v48, v48, v49
    v_pk_fma_f32 v[40:41], v[32:33], v[48:49], v[40:41] op_sel_hi:[1,0,1] neg_lo:[0,1,0] neg_hi:[0,1,0]
    v_pk_add_f32 v[40:41], v[40:41], v[60:61]
    v_or3_b32 v52, v52, v59, v60
    v_max_f32 v50, 0, v50
    s_waitcnt vmcnt(7)
    v_xor_b32 v62, s27, v62
    v_xor_b32 v63, s27, v63
    v_add_f32 v50, s86, v50
    v_pk_add_f32 v[40:41], v[40:41], v[62:63]
    v_or3_b32 v52, v52, v61, v62
    v_rsq_f32 v50, v50
    s_waitcnt vmcnt(6)
    v_xor_b32 v64, s27, v64
    v_xor_b32 v65, s27, v65
    v_or3_b32 v52, v52, v63, v64
    v_pk_add_f32 v[40:41], v[40:41], v[64:65]
    v_bitop3_b32 v52, v52, v65, v0 bitop3:0xa8
    v_cmp_ne_u32 vcc, 0, v52
    v_pk_mul_f32 v[40:41], v[40:41], v[50:51] op_sel_hi:[1,0]
    v_cvt_pk_bf16_f32 v40, v40, v41
    s_cbranch_vccz L_ak_116
L_af_117:
    buffer_load_dwordx2 v[66:67], v17, s[4:7], 0 offen sc1
    buffer_load_dwordx2 v[56:57], v16, s[4:7], s80 offen offset:0 sc1
    buffer_load_dwordx2 v[58:59], v16, s[4:7], s80 offen offset:128 sc1
    buffer_load_dwordx2 v[60:61], v16, s[4:7], s80 offen offset:256 sc1
    buffer_load_dwordx2 v[62:63], v16, s[4:7], s80 offen offset:384 sc1
    buffer_load_dwordx2 v[64:65], v16, s[4:7], s80 offen offset:512 sc1
L_pad1_8:
    s_cbranch_execz L_pad1_9
    s_waitcnt vmcnt(11)
    v_cmp_ne_u32 vcc, s73, v79
    v_add_f32_dpp v48, v78, v78 quad_perm:[1,0,3,2] row_mask:0xf bank_mask:0xf
    s_and_b64 vcc, vcc, s[8:9]
    s_cbranch_scc1 L_af_118
    s_waitcnt vmcnt(9)
    v_xor_b32 v68, s27, v68
    v_xor_b32 v69, s27, v69
    v_add_f32_dpp v48, v48, v48 quad_perm:[2,3,0,1] row_mask:0xf bank_mask:0xf
    v_xor_b32 v70, s27, v70
    v_xor_b32 v71, s27, v71
    v_add_f32_dpp v48, v48, v48 row_half_mirror row_mask:0xf bank_mask:0xf
    v_mul_f32 v48, s85, v48
    v_pk_add_f32 v[40:41], v[68:69], v[70:71]
    v_or3_b32 v52, v68, v69, v70
    v_mov_b32_dpp v49, v48 row_newbcast:8 row_mask:0xf bank_mask:0xf
    v_mov_b32_dpp v48, v48 row_newbcast:0 row_mask:0xf bank_mask:0xf
    s_waitcnt vmcnt(8)
    v_xor_b32 v72, s27, v72
    v_xor_b32 v73, s27, v73
    v_fma_f32 v50, -v48, v48, v49
    v_pk_fma_f32 v[40:41], v[32:33], v[48:49], v[40:41] op_sel_hi:[1,0,1] neg_lo:[0,1,0] neg_hi:[0,1,0]
    v_pk_add_f32 v[40:41], v[40:41], v[72:73]
    v_or3_b32 v52, v52, v71, v72
    v_max_f32 v50, 0, v50
    s_waitcnt vmcnt(7)
    v_xor_b32 v74, s27, v74
    v_xor_b32 v75, s27, v75
    v_add_f32 v50, s86, v50
    v_pk_add_f32 v[40:41], v[40:41], v[74:75]
    v_or3_b32 v52, v52, v73, v74
    v_rsq_f32 v50, v50
    s_waitcnt vmcnt(6)
    v_xor_b32 v76, s27, v76
    v_xor_b32 v77, s27, v77
    v_or3_b32 v52, v52, v75, v76
    v_pk_add_f32 v[40:41], v[40:41], v[76:77]
    v_bitop3_b32 v52, v52, v77, v0 bitop3:0xa8
    v_cmp_ne_u32 vcc, 0, v52
    v_pk_mul_f32 v[40:41], v[40:41], v[50:51] op_sel_hi:[1,0]
    v_cvt_pk_bf16_f32 v40, v40, v41
    s_cbranch_vccz L_ak_116
L_af_118:
    buffer_load_dwordx2 v[78:79], v17, s[4:7], 0 offen sc1
    buffer_load_dwordx2 v[68:69], v16, s[4:7], s80 offen offset:0 sc1
L_pad1_9:
    s_cbranch_execz L_pad1_10
    buffer_load_dwordx2 v[70:71], v16, s[4:7], s80 offen offset:128 sc1
    buffer_load_dwordx2 v[72:73], v16, s[4:7], s80 offen offset:256 sc1
    buffer_load_dwordx2 v[74:75], v16, s[4:7], s80 offen offset:384 sc1
    buffer_load_dwordx2 v[76:77], v16, s[4:7], s80 offen offset:512 sc1
    s_add_u32 s67, s67, 1
    s_cmp_lt_u32 s67, 1048576
    s_cbranch_scc1 L_ap_115
L_ak_116:
    ds_write_b16 v18, v40
    ds_write_b16_d16_hi v18, v40 offset:32
L_ai_j_114:
    s_waitcnt lgkmcnt(0)
    s_barrier
    ds_read_b128 v[88:91], v19
    ds_read_b128 v[92:95], v19 offset:128
    s_waitcnt lgkmcnt(1)
    v_smfmac_f32_16x16x64_bf16 v[96:99], v[88:91], a[0:7], v2
    v_smfmac_f32_16x16x64_bf16 v[100:103], v[88:91], a[16:23], v2
    s_waitcnt lgkmcnt(0)
    v_smfmac_f32_16x16x64_bf16 v[96:99], v[92:95], a[8:15], v2
    v_smfmac_f32_16x16x64_bf16 v[100:103], v[92:95], a[24:31], v2
    v_smfmac_f32_16x16x64_bf16 v[104:107], v[88:91], a[32:39], v2
    v_smfmac_f32_16x16x64_bf16 v[104:107], v[92:95], a[40:47], v2
    v_smfmac_f32_16x16x64_bf16 v[108:111], v[88:91], a[48:55], v2
    v_smfmac_f32_16x16x64_bf16 v[108:111], v[92:95], a[56:63], v2
    v_smfmac_f32_16x16x64_bf16 v[112:115], v[88:91], a[64:71], v2
    v_smfmac_f32_16x16x64_bf16 v[112:115], v[92:95], a[72:79], v2
    v_smfmac_f32_16x16x64_bf16 v[116:119], v[88:91], a[80:87], v2
    v_smfmac_f32_16x16x64_bf16 v[116:119], v[92:95], a[88:95], v2
    v_add_f32 v96, v96, v97
    v_add_f32 v100, v100, v101
    v_smfmac_f32_16x16x64_bf16 v[120:123], v[88:91], a[96:103], v2
    v_smfmac_f32_16x16x64_bf16 v[120:123], v[92:95], a[104:111], v2
    v_add_f32 v104, v104, v105
    v_smfmac_f32_16x16x64_bf16 v[124:127], v[88:91], a[112:119], v2
L_pad1_10:
    s_cbranch_execz L_pad1_11
    v_smfmac_f32_16x16x64_bf16 v[124:127], v[92:95], a[120:127], v2
    v_add_f32 v108, v108, v109
    v_max3_f32 v40, v96, v100, v104
    v_add_f32 v112, v112, v113
    v_add_f32 v116, v116, v117
    v_max3_f32 v40, v40, v108, v112
    v_add_f32 v120, v120, v121
    v_max3_f32 v40, v40, v116, v120
    s_nop 0
    v_add_f32 v124, v124, v125
    v_max_f32 v40, v40, v124
    v_mov_b32_dpp v96, v104 quad_perm:[0,1,2,3] row_mask:0x2 bank_mask:0xf
    v_mov_b32_dpp v100, v108 quad_perm:[0,1,2,3] row_mask:0x2 bank_mask:0xf
    v_max_f32_dpp v40, v40, v40 row_ror:8 row_mask:0xf bank_mask:0xf
    v_mov_b32_dpp v96, v112 quad_perm:[0,1,2,3] row_mask:0x4 bank_mask:0xf
    v_mov_b32_dpp v100, v116 quad_perm:[0,1,2,3] row_mask:0x4 bank_mask:0xf
    v_max_f32_dpp v40, v40, v40 row_ror:4 row_mask:0xf bank_mask:0xf
    v_mov_b32_dpp v96, v120 quad_perm:[0,1,2,3] row_mask:0x8 bank_mask:0xf
    v_mov_b32_dpp v100, v124 quad_perm:[0,1,2,3] row_mask:0x8 bank_mask:0xf
    v_max_f32_dpp v40, v40, v40 row_ror:2 row_mask:0xf bank_mask:0xf
    s_nop 1
    v_max_f32_dpp v40, v40, v40 row_ror:1 row_mask:0xf bank_mask:0xf
    v_mul_f32 v34, s87, v40
    v_fma_f32 v41, v96, s87, -v34
    v_fma_f32 v42, v100, s87, -v34
    v_exp_f32 v41, v41
    v_exp_f32 v42, v42
    s_nop 0
    v_cvt_pk_bf16_f32 v43, v41, v42
    ds_write_b32 v20, v43
    ds_read_b128 v[88:91], v21
    ds_read_b128 v[92:95], v21 offset:128
    ds_write_b32 v22, v34
    v_add_f32 v36, v41, v42
    s_nop 1
    v_add_f32_dpp v36, v36, v36 row_ror:8 row_mask:0xf bank_mask:0xf
    s_nop 1
    v_add_f32_dpp v36, v36, v36 row_ror:4 row_mask:0xf bank_mask:0xf
    s_nop 1
    v_add_f32_dpp v36, v36, v36 row_ror:2 row_mask:0xf bank_mask:0xf
L_pad1_11:
    s_cbranch_execz L_walk_back
    s_nop 1
    v_add_f32_dpp v36, v36, v36 row_ror:1 row_mask:0xf bank_mask:0xf
    v_mov_b32 v52, s93
    s_cmp_eq_u32 s66, 0
    s_cbranch_scc1 L_slow_119
    buffer_store_dword v52, v29, s[4:7], s15 offen offset:0
L_pubd_120:
    s_add_u32 s73, s93, 3
    s_and_b32 s27, s73, 0xff
    s_waitcnt lgkmcnt(2)
    v_smfmac_f32_16x16x64_bf16 v[128:131], v[88:91], a[128:135], v2
    v_smfmac_f32_16x16x64_bf16 v[132:135], v[88:91], a[144:151], v2
    s_waitcnt lgkmcnt(0)
    v_smfmac_f32_16x16x64_bf16 v[128:131], v[92:95], a[136:143], v2
    s_barrier
    ds_read_b128 v[44:47], v28 offset:2816
    v_smfmac_f32_16x16x64_bf16 v[132:135], v[92:95], a[152:159], v2
    v_add_f32_dpp v36, v36, v36 row_bcast:15 row_mask:0xa bank_mask:0xf
    v_smfmac_f32_16x16x64_bf16 v[136:139], v[88:91], a[160:167], v2
    v_smfmac_f32_16x16x64_bf16 v[136:139], v[92:95], a[168:175], v2
    v_add_f32_dpp v36, v36, v36 row_bcast:31 row_mask:0xc bank_mask:0xf
    v_smfmac_f32_16x16x64_bf16 v[140:143], v[88:91], a[176:183], v2
    v_smfmac_f32_16x16x64_bf16 v[140:143], v[92:95], a[184:191], v2
    s_waitcnt lgkmcnt(0)
    v_max3_f32 v44, v44, v45, v46
    v_smfmac_f32_16x16x64_bf16 v[144:147], v[88:91], a[192:199], v2
    v_smfmac_f32_16x16x64_bf16 v[144:147], v[92:95], a[200:207], v2
    v_max_f32 v44, v44, v47
    v_add_f32_dpp v48, v128, v129 quad_perm:[0,1,2,3] row_mask:0x1 bank_mask:0xf
    v_smfmac_f32_16x16x64_bf16 v[148:151], v[88:91], a[208:215], v2
    v_smfmac_f32_16x16x64_bf16 v[148:151], v[92:95], a[216:223], v2
    v_sub_f32 v35, v34, v44
    v_mov_b32 v34, v44
    v_add_f32_dpp v49, v132, v133 quad_perm:[0,1,2,3] row_mask:0x1 bank_mask:0xf
    v_smfmac_f32_16x16x64_bf16 v[152:155], v[88:91], a[224:231], v2
    v_smfmac_f32_16x16x64_bf16 v[152:155], v[92:95], a[232:239], v2
    v_exp_f32 v35, v35
    v_add_f32_dpp v48, v136, v137 quad_perm:[0,1,2,3] row_mask:0x2 bank_mask:0xf
    v_smfmac_f32_16x16x64_bf16 v[156:159], v[88:91], a[240:247], v2
L_pad2_0:
    s_cbranch_execz L_pad2_1
    v_smfmac_f32_16x16x64_bf16 v[156:159], v[92:95], a[248:255], v2
    v_mul_f32 v36, v36, v35
    ds_write_b32 v23, v36
    v_add_f32_dpp v49, v140, v141 quad_perm:[0,1,2,3] row_mask:0x2 bank_mask:0xf
    v_add_f32_dpp v48, v144, v145 quad_perm:[0,1,2,3] row_mask:0x4 bank_mask:0xf
    s_nop 0
    v_add_f32_dpp v49, v148, v149 quad_perm:[0,1,2,3] row_mask:0x4 bank_mask:0xf
    v_add_f32_dpp v48, v152, v153 quad_perm:[0,1,2,3] row_mask:0x8 bank_mask:0xf
    s_nop 0
    v_add_f32_dpp v49, v156, v157 quad_perm:[0,1,2,3] row_mask:0x8 bank_mask:0xf
    v_mul_f32 v48, v48, v35
    v_mul_f32 v49, v49, v35
    ds_write2_b32 v24, v48, v49 offset0:0 offset1:16
    s_cmp_lg_u32 s56, 0
    s_waitcnt lgkmcnt(0)
    s_barrier
    s_cbranch_scc1 L_ae1_121
    ds_read_b64 v[40:41], v25 offset:0
    ds_read_b64 v[42:43], v25 offset:512
    ds_read_b64 v[44:45], v25 offset:1024
    ds_read_b64 v[46:47], v25 offset:1536
    s_cmp_eq_u32 s66, 0
    s_waitcnt lgkmcnt(2)
    v_pk_add_f32 v[40:41], v[40:41], v[42:43]
    s_waitcnt lgkmcnt(1)
    v_pk_add_f32 v[40:41], v[40:41], v[44:45]
    s_waitcnt lgkmcnt(0)
    v_pk_add_f32 v[40:41], v[40:41], v[46:47]
    v_cvt_pk_bf16_f32 v40, v40, v41
    v_min_u32 v40, -2, v40
    s_cbranch_scc1 L_slow_123
    buffer_store_dword v40, v26, s[4:7], s75 offen
L_pubd_124:
    s_branch L_aed_122
L_pad2_1:
    s_branch L_pad2_2
L_ae1_121:
    s_cmp_lg_u32 s56, 1
    s_cbranch_scc1 L_aed_122
    ds_read_b128 v[44:47], v28 offset:2832
    v_min_u32 v40, -2, v34
    s_waitcnt lgkmcnt(0)
    v_pk_add_f32 v[44:45], v[44:45], v[46:47]
    v_add_f32 v41, v44, v45
    v_min_u32 v41, -2, v41
    s_cmp_eq_u32 s66, 0
    s_cbranch_scc1 L_slow_125
    buffer_store_dwordx2 v[40:41], v27, s[4:7], s76 offen
L_pubd_126:
L_aed_122:
    s_branch L_a_done
L_final:
    s_cmp_lg_u32 s57, 7
    s_cbranch_scc1 L_end_prof
    s_cmp_lg_u32 s56, s58
    s_cbranch_scc1 L_end_prof
    v_and_b32 v48, 31, v1
    v_lshrrev_b32 v49, 5, v1
    v_lshlrev_b32 v48, 3, v48
    v_lshl_or_b32 v48, v49, 2, v48
    s_mul_i32 s71, s56, 1280
    s_lshl_b32 s72, s59, 8
    s_add_u32 s71, s71, s72
    v_add_u32 v48, s71, v48
    s_add_u32 s69, s92, s3
    s_add_u32 s71, s78, s3
L_hl_130:
    buffer_load_dword v72, v248, s[48:51], s69 offen sc1
    s_waitcnt vmcnt(0)
    v_cmp_ne_u32 vcc, s93, v72
    s_cmp_eq_u32 vcc_lo, 0
    s_cbranch_scc1 L_hk_131
    v_readlane_b32 s70, v72, 63
    s_add_u32 s67, s67, 1
    s_xor_b32 s70, s70, s93
    s_andn2_b32 s72, s70, 0x2000
    s_cselect_b32 s3, s3, s70
    s_add_u32 s69, s92, s3
    s_add_u32 s71, s78, s3
    s_cmp_lt_u32 s67, 1048576
    s_cbranch_scc1 L_hl_130
L_hk_131:
L_xg_127:
    buffer_load_dwordx4 v[56:59], v10, s[48:51], s71 offen offset:0 sc1
    buffer_load_dwordx4 v[60:63], v10, s[48:51], s71 offen offset:1024 sc1
    buffer_load_dwordx4 v[64:67], v10, s[48:51], s71 offen offset:2048 sc1
    buffer_load_dwordx4 v[68:71], v10, s[48:51], s71 offen offset:3072 sc1
L_pad2_2:
    s_cbranch_execz L_pad2_3
    s_waitcnt vmcnt(3)
    v_xor_b32 v56, s26, v56
    v_xor_b32 v57, s26, v57
    v_xor_b32 v58, s26, v58
    v_xor_b32 v59, s26, v59
    s_waitcnt vmcnt(2)
    v_xor_b32 v60, s26, v60
    v_xor_b32 v61, s26, v61
    v_xor_b32 v62, s26, v62
    v_xor_b32 v63, s26, v63
    v_pk_add_f32 v[40:41], v[56:57], v[60:61]
    v_pk_add_f32 v[42:43], v[58:59], v[62:63]
    v_or3_b32 v44, v56, v57, v58
    v_or3_b32 v44, v44, v59, v60
    v_or3_b32 v44, v44, v61, v62
    s_waitcnt vmcnt(1)
    v_xor_b32 v64, s26, v64
    v_xor_b32 v65, s26, v65
    v_xor_b32 v66, s26, v66
    v_xor_b32 v67, s26, v67
    v_pk_add_f32 v[40:41], v[40:41], v[64:65]
    v_pk_add_f32 v[42:43], v[42:43], v[66:67]
    v_or3_b32 v44, v44, v63, v64
    v_or3_b32 v44, v44, v65, v66
    s_waitcnt vmcnt(0)
    v_xor_b32 v68, s26, v68
    v_xor_b32 v69, s26, v69
    v_xor_b32 v70, s26, v70
    v_xor_b32 v71, s26, v71
    v_pk_add_f32 v[40:41], v[40:41], v[68:69]
    v_pk_add_f32 v[42:43], v[42:43], v[70:71]
    v_or3_b32 v44, v44, v67, v68
    v_or3_b32 v44, v44, v69, v70
    v_permlane32_swap_b32 v40, v42
    v_permlane32_swap_b32 v41, v43
    v_bitop3_b32 v44, v44, v71, v0 bitop3:0xa8
    v_pk_add_f32 v[40:41], v[40:41], v[42:43]
    v_cmp_ne_u32 vcc, 0, v44
    v_pk_add_f32 v[40:41], v[40:41], v[30:31]
    v_cvt_pk_bf16_f32 v37, v40, v41
    s_cbranch_vccnz L_xgr_128
L_xgk_129:
    s_add_u32 s92, s92, 32768
    global_store_dword v48, v37, s[34:35]
    v_mov_b32 v49, s73
    v_mov_b32 v50, 1556480
L_pad2_3:
    s_cbranch_execz L_pad2_4
    s_mov_b64 exec, 1
    s_cmp_lg_u32 s2, 7
    s_cbranch_scc1 L_notag
    buffer_store_dword v49, v50, s[48:51], 0 offen
L_notag:
    s_mov_b64 exec, -1
    s_branch L_end_prof
L_od:
    v_mov_b32 v96, 0
    v_mov_b32 v97, 0
    v_mov_b32 v98, 0
    v_mov_b32 v99, 0
    v_mov_b32 v100, 0
    v_mov_b32 v101, 0
    v_mov_b32 v102, 0
    v_mov_b32 v103, 0
    v_mov_b32 v104, 0
    v_mov_b32 v105, 0
    v_mov_b32 v106, 0
    v_mov_b32 v107, 0
    v_mov_b32 v108, 0
    v_mov_b32 v109, 0
    v_mov_b32 v110, 0
    v_mov_b32 v111, 0
    s_cmp_lg_u32 s68, 0
    s_cbranch_scc1 L_o2_132
    v_and_b32 v55, 31, v1
    s_lshl_b32 s72, s56, 7
    v_lshl_add_u32 v55, v55, 2, s72
    s_waitcnt vmcnt(12)
    ds_read_b64_tr_b16 v[160:161], v6 offset:0
    ds_read_b64_tr_b16 v[162:163], v6 offset:512
    ds_read_b64_tr_b16 v[176:177], v7 offset:0
    ds_read_b64_tr_b16 v[178:179], v7 offset:512
    ds_read_b64_tr_b16 v[192:193], v8 offset:0
    ds_read_b64_tr_b16 v[194:195], v8 offset:512
    ds_read_b64_tr_b16 v[208:209], v9 offset:0
    ds_read_b64_tr_b16 v[210:211], v9 offset:512
    s_waitcnt vmcnt(8)
    ds_read_b64_tr_b16 v[164:165], v6 offset:4096
    ds_read_b64_tr_b16 v[166:167], v6 offset:4608
    ds_read_b64_tr_b16 v[180:181], v7 offset:4096
    ds_read_b64_tr_b16 v[182:183], v7 offset:4608
    ds_read_b64_tr_b16 v[196:197], v8 offset:4096
    ds_read_b64_tr_b16 v[198:199], v8 offset:4608
    ds_read_b64_tr_b16 v[212:213], v9 offset:4096
    ds_read_b64_tr_b16 v[214:215], v9 offset:4608
L_pad2_4:
    s_cbranch_execz L_pad2_5
    s_waitcnt vmcnt(4)
    ds_read_b64_tr_b16 v[168:169], v6 offset:8192
    ds_read_b64_tr_b16 v[170:171], v6 offset:8704
    ds_read_b64_tr_b16 v[184:185], v7 offset:8192
    ds_read_b64_tr_b16 v[186:187], v7 offset:8704
    ds_read_b64_tr_b16 v[200:201], v8 offset:8192
    ds_read_b64_tr_b16 v[202:203], v8 offset:8704
    ds_read_b64_tr_b16 v[216:217], v9 offset:8192
    ds_read_b64_tr_b16 v[218:219], v9 offset:8704
    s_waitcnt vmcnt(2)
    v_mov_b32 v53, s93
    s_cmp_eq_u32 s66, 0
    s_cbranch_scc1 L_slow_134
    buffer_store_dword v53, v29, s[4:7], s15 offen offset:512
L_pubd_135:
    buffer_load_dword v54, v55, s[4:7], s15 offen sc1
L_o2_132:
    buffer_load_dwordx4 v[64:67], v11, s[4:7], s76 offen sc1
    buffer_load_dwordx4 v[56:59], v10, s[4:7], s75 offen sc1
    buffer_load_dwordx4 v[60:63], v10, s[4:7], s75 offen offset:1024 sc1
    s_cmp_lg_u32 s68, 0
    s_cbranch_scc1 L_o3_133
    s_waitcnt vmcnt(5)
    ds_read_b64_tr_b16 v[172:173], v6 offset:12288
    ds_read_b64_tr_b16 v[174:175], v6 offset:12800
    ds_read_b64_tr_b16 v[188:189], v7 offset:12288
    ds_read_b64_tr_b16 v[190:191], v7 offset:12800
    ds_read_b64_tr_b16 v[204:205], v8 offset:12288
    ds_read_b64_tr_b16 v[206:207], v8 offset:12800
    ds_read_b64_tr_b16 v[220:221], v9 offset:12288
    ds_read_b64_tr_b16 v[222:223], v9 offset:12800
    s_waitcnt vmcnt(3)
L_oc_141:
    v_cmp_ne_u32 vcc, s93, v54
    s_cbranch_vccnz L_orr_142
L_ok_144:
    s_waitcnt lgkmcnt(0)
    s_branch L_o4_136
L_pad2_5:
    s_branch L_pad2_6
L_o3_133:
    s_nop 15
    s_nop 15
L_o4_136:
    buffer_load_dwordx4 v[76:79], v11, s[4:7], s76 offen sc1
    buffer_load_dwordx4 v[68:71], v10, s[4:7], s75 offen sc1
    buffer_load_dwordx4 v[72:75], v10, s[4:7], s75 offen offset:1024 sc1
L_pp_137:
    s_waitcnt vmcnt(5)
    v_max_f32 v52, v64, v66
    v_max3_u32 v40, v64, v65, v66
    v_sub_f32 v48, v64, v52
    v_sub_f32 v50, v66, v52
    v_exp_f32 v48, v48
    v_exp_f32 v50, v50
    s_waitcnt vmcnt(4)
    v_max3_u32 v40, v40, v67, v56
    v_max3_u32 v40, v40, v57, v58
    s_waitcnt vmcnt(3)
    v_max3_u32 v40, v40, v59, v60
    v_max3_u32 v41, v61, v62, v63
    v_max_u32 v40, v40, v41
    v_cmp_eq_u32 vcc, -1, v40
    s_cbranch_vccz L_pk_139
    buffer_load_dwordx4 v[64:67], v11, s[4:7], s76 offen sc1
    buffer_load_dwordx4 v[56:59], v10, s[4:7], s75 offen sc1
    buffer_load_dwordx4 v[60:63], v10, s[4:7], s75 offen offset:1024 sc1
L_pad2_6:
    s_cbranch_execz L_pad2_7
    s_waitcnt vmcnt(5)
    v_max_f32 v52, v76, v78
    v_max3_u32 v40, v76, v77, v78
    v_sub_f32 v48, v76, v52
    v_sub_f32 v50, v78, v52
    v_exp_f32 v48, v48
    v_exp_f32 v50, v50
    s_waitcnt vmcnt(4)
    v_max3_u32 v40, v40, v79, v68
    v_max3_u32 v40, v40, v69, v70
    s_waitcnt vmcnt(3)
    v_max3_u32 v40, v40, v71, v72
    v_max3_u32 v41, v73, v74, v75
    v_max_u32 v40, v40, v41
    v_cmp_eq_u32 vcc, -1, v40
    s_cbranch_vccz L_pk_140
    buffer_load_dwordx4 v[76:79], v11, s[4:7], s76 offen sc1
    buffer_load_dwordx4 v[68:71], v10, s[4:7], s75 offen sc1
    buffer_load_dwordx4 v[72:75], v10, s[4:7], s75 offen offset:1024 sc1
    s_add_u32 s67, s67, 1
    s_cmp_lt_u32 s67, 1048576
    s_cbranch_scc1 L_pp_137
    s_waitcnt vmcnt(0)
L_pk_139:
    v_smfmac_f32_16x16x64_bf16 v[96:99], v[56:59], v[160:167], v2
    v_mul_f32 v52, v65, v48
    v_smfmac_f32_16x16x64_bf16 v[96:99], v[60:63], v[168:175], v2
    v_fmac_f32 v52, v67, v50
    v_smfmac_f32_16x16x64_bf16 v[100:103], v[56:59], v[176:183], v2
    v_rcp_f32 v52, v52
    v_smfmac_f32_16x16x64_bf16 v[100:103], v[60:63], v[184:191], v2
    v_smfmac_f32_16x16x64_bf16 v[104:107], v[56:59], v[192:199], v2
    v_mul_f32 v48, v48, v52
    v_mul_f32 v50, v50, v52
    v_smfmac_f32_16x16x64_bf16 v[104:107], v[60:63], v[200:207], v2
L_pad2_7:
    s_cbranch_execz L_pad2_8
    v_smfmac_f32_16x16x64_bf16 v[108:111], v[56:59], v[208:215], v2
    v_pk_mul_f32 v[96:97], v[96:97], v[48:49] op_sel_hi:[1,0]
    v_pk_fma_f32 v[96:97], v[98:99], v[50:51], v[96:97] op_sel_hi:[1,0,1]
    v_smfmac_f32_16x16x64_bf16 v[108:111], v[60:63], v[216:223], v2
    v_add_f32 v96, v96, v97
    ds_write_b32 v13, v96 offset:0
    v_pk_mul_f32 v[100:101], v[100:101], v[48:49] op_sel_hi:[1,0]
    v_pk_fma_f32 v[100:101], v[102:103], v[50:51], v[100:101] op_sel_hi:[1,0,1]
    v_add_f32 v100, v100, v101
    ds_write_b32 v13, v100 offset:64
    s_branch L_pj_138
L_pk_140:
    v_smfmac_f32_16x16x64_bf16 v[96:99], v[68:71], v[160:167], v2
    v_mul_f32 v52, v77, v48
    v_smfmac_f32_16x16x64_bf16 v[96:99], v[72:75], v[168:175], v2
    v_fmac_f32 v52, v79, v50
    v_smfmac_f32_16x16x64_bf16 v[100:103], v[68:71], v[176:183], v2
    v_rcp_f32 v52, v52
    v_smfmac_f32_16x16x64_bf16 v[100:103], v[72:75], v[184:191], v2
    v_smfmac_f32_16x16x64_bf16 v[104:107], v[68:71], v[192:199], v2
    v_mul_f32 v48, v48, v52
    v_mul_f32 v50, v50, v52
    v_smfmac_f32_16x16x64_bf16 v[104:107], v[72:75], v[200:207], v2
L_pad2_8:
    s_cbranch_execz L_pad2_9
    v_smfmac_f32_16x16x64_bf16 v[108:111], v[68:71], v[208:215], v2
    v_pk_mul_f32 v[96:97], v[96:97], v[48:49] op_sel_hi:[1,0]
    v_pk_fma_f32 v[96:97], v[98:99], v[50:51], v[96:97] op_sel_hi:[1,0,1]
    v_smfmac_f32_16x16x64_bf16 v[108:111], v[72:75], v[216:223], v2
    v_add_f32 v96, v96, v97
    ds_write_b32 v13, v96 offset:0
    v_pk_mul_f32 v[100:101], v[100:101], v[48:49] op_sel_hi:[1,0]
    v_pk_fma_f32 v[100:101], v[102:103], v[50:51], v[100:101] op_sel_hi:[1,0,1]
    v_add_f32 v100, v100, v101
    ds_write_b32 v13, v100 offset:64
L_pj_138:
    v_pk_mul_f32 v[104:105], v[104:105], v[48:49] op_sel_hi:[1,0]
    v_pk_fma_f32 v[104:105], v[106:107], v[50:51], v[104:105] op_sel_hi:[1,0,1]
    v_add_f32 v104, v104, v105
    ds_write_b32 v13, v104 offset:128
    v_pk_mul_f32 v[108:109], v[108:109], v[48:49] op_sel_hi:[1,0]
    v_pk_fma_f32 v[108:109], v[110:111], v[50:51], v[108:109] op_sel_hi:[1,0,1]
    v_add_f32 v108, v108, v109
    ds_write_b32 v13, v108 offset:192
    s_cmp_ge_u32 s56, 2
    s_waitcnt lgkmcnt(0)
    s_barrier
    s_cbranch_scc1 L_odf_145
    ds_read_b128 v[40:43], v14 offset:0
    ds_read_b128 v[44:47], v14 offset:1024
    ds_read_b128 v[48:51], v14 offset:2048
    ds_read_b128 v[52:55], v14 offset:3072
L_pad2_9:
    s_cbranch_execz L_pad2_10
    s_waitcnt lgkmcnt(2)
    v_pk_add_f32 v[40:41], v[40:41], v[44:45]
    v_pk_add_f32 v[42:43], v[42:43], v[46:47]
    s_waitcnt lgkmcnt(1)
    v_pk_add_f32 v[40:41], v[40:41], v[48:49]
    v_pk_add_f32 v[42:43], v[42:43], v[50:51]
    s_waitcnt lgkmcnt(0)
    v_pk_add_f32 v[40:41], v[40:41], v[52:53]
    v_pk_add_f32 v[42:43], v[42:43], v[54:55]
    v_bfi_b32 v40, v0, s93, v40
    v_bfi_b32 v41, v0, s93, v41
    v_bfi_b32 v42, v0, s93, v42
    v_bfi_b32 v43, v0, s93, v43
    buffer_store_dwordx4 v[40:43], v15, s[48:51], s77 offen sc1
L_odf_145:
    s_cmp_lg_u32 s68, 0
    s_cbranch_scc1 L_od_d
    s_lshl_b32 s70, s56, 3
    s_add_u32 s70, s70, s57
    s_mul_i32 s70, s70, 81920
    s_lshl_b32 s72, s82, 7
    s_add_u32 s70, s70, s72
    s_add_u32 s52, s32, s70
    s_addc_u32 s53, s33, 0
    s_mov_b32 s54, 0
    s_mov_b32 s55, 0x20000
    s_mul_i32 s54, s62, 80768
    s_mov_b32 m0, s64
    s_mov_b32 s63, 0
    buffer_load_dwordx4 v4, s[52:55], s63 offen nt lds
    s_addk_i32 m0, 1024
    s_add_u32 s63, s63, s65
    buffer_load_dwordx4 v5, s[52:55], s63 offen nt lds
    s_addk_i32 m0, 1024
    s_add_u32 s63, s63, s65
    buffer_load_dwordx4 v4, s[52:55], s63 offen nt lds
    s_addk_i32 m0, 1024
    s_add_u32 s63, s63, s65
    buffer_load_dwordx4 v5, s[52:55], s63 offen nt lds
    s_addk_i32 m0, 1024
    s_add_u32 s63, s63, s65
    buffer_load_dwordx4 v4, s[52:55], s63 offen nt lds
    s_addk_i32 m0, 1024
    s_add_u32 s63, s63, s65
    buffer_load_dwordx4 v5, s[52:55], s63 offen nt lds
L_pad2_10:
    s_cbranch_execz L_pad2_11
    s_addk_i32 m0, 1024
    s_add_u32 s63, s63, s65
    buffer_load_dwordx4 v4, s[52:55], s63 offen nt lds
    s_addk_i32 m0, 1024
    s_add_u32 s63, s63, s65
    buffer_load_dwordx4 v5, s[52:55], s63 offen nt lds
    s_addk_i32 m0, 1024
    s_add_u32 s63, s63, s65
    s_cmp_ge_u32 s56, 2
    s_cbranch_scc1 L_tp_146
    s_mov_b32 s70, 917504
    buffer_load_dword v79, v15, s[48:51], s70 offen
    s_mov_b32 s70, 1081344
    buffer_load_dword v79, v15, s[48:51], s70 offen
    s_mov_b32 s70, 1245184
    buffer_load_dword v79, v15, s[48:51], s70 offen
L_tp_146:
    s_waitcnt vmcnt(0)
    ds_read_b64_tr_b16 v[224:225], v6 offset:0
    ds_read_b64_tr_b16 v[226:227], v6 offset:512
    ds_read_b64_tr_b16 v[232:233], v7 offset:0
    ds_read_b64_tr_b16 v[234:235], v7 offset:512
    ds_read_b64_tr_b16 v[240:241], v8 offset:0
    ds_read_b64_tr_b16 v[242:243], v8 offset:512
    ds_read_b64_tr_b16 v[248:249], v9 offset:0
    ds_read_b64_tr_b16 v[250:251], v9 offset:512
    ds_read_b64_tr_b16 v[228:229], v6 offset:4096
    ds_read_b64_tr_b16 v[230:231], v6 offset:4608
    ds_read_b64_tr_b16 v[236:237], v7 offset:4096
    ds_read_b64_tr_b16 v[238:239], v7 offset:4608
    ds_read_b64_tr_b16 v[244:245], v8 offset:4096
    ds_read_b64_tr_b16 v[246:247], v8 offset:4608
    ds_read_b64_tr_b16 v[252:253], v9 offset:4096
    ds_read_b64_tr_b16 v[254:255], v9 offset:4608
L_pad2_11:
    s_cbranch_execz L_walk_back
    s_waitcnt lgkmcnt(0)
L_od_d:
    v_mov_b32 v96, 0
    v_mov_b32 v97, 0
    v_mov_b32 v98, 0
    v_mov_b32 v99, 0
    v_mov_b32 v100, 0
    v_mov_b32 v101, 0
    v_mov_b32 v102, 0
    v_mov_b32 v103, 0
    v_mov_b32 v104, 0
    v_mov_b32 v105, 0
    v_mov_b32 v106, 0
    v_mov_b32 v107, 0
    v_mov_b32 v108, 0
    v_mov_b32 v109, 0
    v_mov_b32 v110, 0
    v_mov_b32 v111, 0
    s_cmp_eq_u32 s62, 0
    s_cbranch_scc1 L_ds_147
    buffer_load_dwordx4 v[56:59], v12, s[4:7], s79 offen sc1
L_pp_148:
    s_waitcnt vmcnt(0)
    v_max3_u32 v40, v56, v57, v58
    v_max_u32 v40, v40, v59
    v_cmp_eq_u32 vcc, -1, v40
    s_cbranch_vccz L_pk_150
    buffer_load_dwordx4 v[56:59], v12, s[4:7], s79 offen sc1
    s_add_u32 s67, s67, 1
    s_cmp_lt_u32 s67, 1048576
    s_cbranch_scc1 L_pp_148
    s_waitcnt vmcnt(0)
L_pk_150:
    v_smfmac_f32_16x16x64_bf16 v[96:99], v[56:59], v[224:231], v2
    v_smfmac_f32_16x16x64_bf16 v[100:103], v[56:59], v[232:239], v2
    v_smfmac_f32_16x16x64_bf16 v[104:107], v[56:59], v[240:247], v2
L_pad3_0:
    s_cbranch_execz L_pad3_1
    v_smfmac_f32_16x16x64_bf16 v[108:111], v[56:59], v[248:255], v2
    s_nop 3
L_pj_149:
L_ds_147:
    s_nop 0
    v_add_f32 v96, v96, v97
    ds_write_b32 v13, v96 offset:4096
    v_add_f32 v100, v100, v101
    ds_write_b32 v13, v100 offset:4160
    v_add_f32 v104, v104, v105
    ds_write_b32 v13, v104 offset:4224
    v_add_f32 v108, v108, v109
    ds_write_b32 v13, v108 offset:4288
    s_cmp_ge_u32 s56, 2
    s_waitcnt lgkmcnt(0)
    s_barrier
    s_cbranch_scc1 L_odf_151
    ds_read_b128 v[40:43], v14 offset:4096
    ds_read_b128 v[44:47], v14 offset:5120
    ds_read_b128 v[48:51], v14 offset:6144
    ds_read_b128 v[52:55], v14 offset:7168
    s_waitcnt lgkmcnt(2)
    v_pk_add_f32 v[40:41], v[40:41], v[44:45]
    v_pk_add_f32 v[42:43], v[42:43], v[46:47]
    s_waitcnt lgkmcnt(1)
    v_pk_add_f32 v[40:41], v[40:41], v[48:49]
    v_pk_add_f32 v[42:43], v[42:43], v[50:51]
    s_waitcnt lgkmcnt(0)
    v_pk_add_f32 v[40:41], v[40:41], v[52:53]
    v_pk_add_f32 v[42:43], v[42:43], v[54:55]
    v_bfi_b32 v40, v0, s93, v40
    v_bfi_b32 v41, v0, s93, v41
    v_bfi_b32 v42, v0, s93, v42
    v_bfi_b32 v43, v0, s93, v43
    buffer_store_dwordx4 v[40:43], v15, s[48:51], s78 offen sc1
L_odf_151:
    s_branch L_next
L_pad3_1:
    s_branch L_pad3_2
L_watch:
    s_cmp_lg_u32 s56, 3
    s_cbranch_scc1 L_next
    s_cmp_lg_u32 s82, 10
    s_cbranch_scc1 L_probe
    v_mov_b32 v41, s93
    s_cmp_lg_u32 s68, 0
    s_cbranch_scc1 L_w1
    buffer_load_dwordx2 v[56:57], v12, s[4:7], s15 offen offset:512 sc1
L_pp_152:
    s_waitcnt vmcnt(0)
    v_xor_b32 v40, s93, v56
    v_bitop3_b32 v40, v40, v57, s93 bitop3:0xf6
    v_cmp_ne_u32 vcc, 0, v40
    s_cbranch_vccz L_pj_153
    buffer_load_dwordx2 v[56:57], v12, s[4:7], s15 offen offset:512 sc1
    s_add_u32 s67, s67, 1
    s_cmp_lt_u32 s67, 1048576
    s_cbranch_scc1 L_pp_152
    s_waitcnt vmcnt(0)
L_pj_153:
L_w1:
    buffer_load_dwordx2 v[56:57], v10, s[4:7], s15 offen sc1
    s_nop 15
    s_nop 15
    buffer_load_dwordx2 v[58:59], v10, s[4:7], s15 offen sc1
L_pp_154:
    s_waitcnt vmcnt(1)
    v_xor_b32 v40, s93, v56
    v_bitop3_b32 v40, v40, v57, s93 bitop3:0xf6
    v_cmp_ne_u32 vcc, 0, v40
    s_cbranch_vccz L_pj_155
    buffer_load_dwordx2 v[56:57], v10, s[4:7], s15 offen sc1
    s_waitcnt vmcnt(1)
    v_xor_b32 v40, s93, v58
    v_bitop3_b32 v40, v40, v59, s93 bitop3:0xf6
    v_cmp_ne_u32 vcc, 0, v40
    s_cbranch_vccz L_pj_155
    buffer_load_dwordx2 v[58:59], v10, s[4:7], s15 offen sc1
    s_add_u32 s67, s67, 1
    s_cmp_lt_u32 s67, 1048576
    s_cbranch_scc1 L_pp_154
    s_waitcnt vmcnt(0)
L_pj_155:
    s_cmp_eq_u32 s68, 0
    s_cbranch_scc1 L_dl_156
    s_sleep 5
    s_branch L_dl_157
L_pad3_2:
    s_branch L_pad3_3
L_dl_156:
    s_sleep 6
L_dl_157:
    buffer_store_dword v41, v248, s[48:51], s92 offen sc1
    s_add_u32 s92, s92, 32768
    s_add_u32 s15, s15, 512
    buffer_load_dwordx2 v[56:57], v11, s[4:7], s15 offen sc1
    s_nop 15
    s_nop 15
    buffer_load_dwordx2 v[58:59], v11, s[4:7], s15 offen sc1
L_pp_158:
    s_waitcnt vmcnt(1)
    v_xor_b32 v40, s93, v56
    v_bitop3_b32 v40, v40, v57, s93 bitop3:0xf6
    v_cmp_ne_u32 vcc, 0, v40
    s_cbranch_vccz L_pj_159
    buffer_load_dwordx2 v[56:57], v11, s[4:7], s15 offen sc1
    s_waitcnt vmcnt(1)
    v_xor_b32 v40, s93, v58
    v_bitop3_b32 v40, v40, v59, s93 bitop3:0xf6
    v_cmp_ne_u32 vcc, 0, v40
    s_cbranch_vccz L_pj_159
    buffer_load_dwordx2 v[58:59], v11, s[4:7], s15 offen sc1
    s_add_u32 s67, s67, 1
    s_cmp_lt_u32 s67, 1048576
    s_cbranch_scc1 L_pp_158
    s_waitcnt vmcnt(0)
L_pj_159:
    s_cmp_lg_u32 s68, 0
    s_cbranch_scc1 L_dl_160
    s_sleep 11
    s_branch L_dl_161
L_dl_160:
    s_sleep 7
L_dl_161:
    buffer_store_dword v41, v248, s[48:51], s92 offen sc1
    s_add_u32 s92, s92, 32768
    s_add_u32 s15, s15, 512
    s_branch L_next
L_pad3_3:
    s_branch L_pad3_4
L_probe:
    s_cmp_lg_u32 s68, 0
    s_cbranch_scc1 L_next
    s_lshl_b32 s72, s57, 10
    s_add_u32 s72, s72, 1409024
    v_mov_b32 v40, 0
    v_mov_b32 v41, 8192
    s_mov_b32 s16, -1
    s_mov_b32 s17, -1
    s_mov_b32 s18, 0
    v_lshrrev_b32 v43, 1, v1
    v_and_b32 v42, 1, v1
    v_lshlrev_b32 v43, 15, v43
    v_lshl_add_u32 v43, v42, 13, v43
    s_lshl_b32 s70, s57, 7
    s_add_u32 s70, s70, 1441792
    s_waitcnt vmcnt(0)
L_probe1:
    s_memtime s[20:21]
    s_waitcnt lgkmcnt(0)
    buffer_load_dword v42, v40, s[48:51], s72 offen sc1
    s_waitcnt vmcnt(0)
    s_memtime s[22:23]
    s_waitcnt lgkmcnt(0)
    s_sub_u32 s22, s22, s20
    s_min_u32 s16, s16, s22
    s_memtime s[20:21]
    s_waitcnt lgkmcnt(0)
    buffer_load_dword v42, v41, s[48:51], s72 offen sc1
    s_waitcnt vmcnt(0)
    s_memtime s[22:23]
    s_waitcnt lgkmcnt(0)
    s_sub_u32 s22, s22, s20
    s_min_u32 s17, s17, s22
    s_add_u32 s72, s72, 128
    s_add_u32 s18, s18, 1
    s_and_b32 s19, s18, 1
    s_cbranch_scc1 L_probe1
    s_cmp_lt_u32 s17, s16
    s_cselect_b32 s19, 0x2000, 0
    s_xor_b32 s19, s19, s93
    v_mov_b32 v42, s19
    s_mov_b64 exec, 0xff
    s_cmp_eq_u32 s66, 0
    s_cbranch_scc1 L_slow_162
    buffer_store_dword v42, v43, s[48:51], s70 offen
L_pubd_163:
    s_mov_b64 exec, -1
    s_waitcnt vmcnt(0)
    s_cmp_lt_u32 s18, 4
    s_cbranch_scc1 L_probe1
    s_branch L_next
L_pad3_4:
    s_branch L_pad3_5
L_end_prof:
L_end:
    s_endpgm
L_slow_7:
    buffer_store_dwordx4 v[40:43], v45, s[4:7], s80 offen sc1
    s_branch L_pubd_8
L_od_setup:
    s_lshl_b32 s71, s57, 2
    s_add_u32 s71, s71, s56
    s_lshl_b32 s72, s56, 11
    v_lshl_add_u32 v10, v1, 4, s72
    s_lshl_b32 s72, s56, 7
    v_lshl_add_u32 v11, v252, 4, s72
    s_lshl_b32 s72, s56, 9
    v_lshrrev_b32 v43, 2, v1
    v_lshl_add_u32 v43, v43, 5, s72
    v_and_b32 v44, 1, v1
    v_lshl_add_u32 v12, v44, 4, v43
    s_lshl_b32 s72, s56, 10
    s_add_u32 s72, s72, 136704
    v_lshl_add_u32 v43, v252, 8, s72
    v_lshl_add_u32 v13, v251, 2, v43
    v_lshlrev_b32 v14, 4, v1
    v_add_u32 v14, 136704, v14
    s_lshr_b32 s72, s82, 1
    s_lshl_b32 s72, s72, 15
    s_lshl_b32 s70, s57, 9
    s_add_u32 s72, s72, s70
    s_and_b32 s70, s82, 1
    s_lshl_b32 s70, s70, 8
    s_add_u32 s72, s72, s70
    s_lshl_b32 s70, s56, 13
    s_add_u32 s72, s72, s70
    v_bfe_u32 v43, v1, 5, 1
    v_lshl_add_u32 v43, v43, 14, s72
    v_bfe_u32 v44, v1, 4, 1
    v_lshl_add_u32 v43, v44, 12, v43
    v_lshl_add_u32 v15, v251, 4, v43
    v_add_u32 v6, s64, v6
    v_xor_b32 v7, 32, v6
    v_xor_b32 v8, 64, v6
    v_xor_b32 v9, 96, v6
    s_lshl_b32 s70, s56, 3
    s_add_u32 s70, s70, s57
    s_cmp_lt_u32 s70, 27
    s_cselect_b32 s62, 1, 0
    s_mul_i32 s71, s71, 163840
    s_lshl_b32 s72, s82, 7
    s_add_u32 s71, s71, s72
    s_add_u32 s52, s24, s71
    s_addc_u32 s53, s25, 0
    s_mov_b32 s54, 162688
L_pad3_5:
    s_cbranch_execz L_pad3_6
    s_mov_b32 s55, 0x20000
    s_cmp_eq_u32 s61, 1
    s_cselect_b32 s54, s54, 0
    s_cselect_b32 s13, 1, 0
    s_mov_b32 s65, 10240
    s_movk_i32 s72, 1280
    s_cbranch_scc1 L_role_done
    v_lshlrev_b32 v10, 3, v1
    v_bfe_u32 v43, v1, 1, 3
    v_cmp_gt_u32 vcc, 5, v43
    s_cmp_lt_u32 s57, 3
    s_cselect_b32 s70, -1, 0xffff
    s_and_b32 vcc_hi, vcc_hi, s70
    v_cndmask_b32 v11, 0, v10, vcc
    v_cmp_le_u32 vcc, 5, v43
    s_and_b32 vcc_hi, vcc_hi, 0x0fffffff
    v_mov_b32 v44, 80
    v_cndmask_b32 v12, v44, v10, vcc
    v_cmp_gt_u32 vcc, 16, v1
    s_lshl_b32 s70, s57, 7
    v_lshl_add_u32 v43, v1, 10, s70
    v_cndmask_b32 v248, v253, v43, vcc
    s_branch L_role_done
L_slow_21:
    buffer_store_dwordx4 v[40:43], v44, s[4:7], s71 offen offset:0 sc1
    buffer_store_dwordx4 v[40:43], v44, s[4:7], s71 offen offset:1024 sc1
    buffer_store_dwordx4 v[40:43], v44, s[4:7], s71 offen offset:2048 sc1
    s_branch L_pubd_22
L_slow_32:
    buffer_store_dwordx4 v[76:79], v80, s[4:7], s72 offen sc1
    s_branch L_pubd_33
L_a0p_60:
    s_sleep 8
    buffer_load_dwordx2 v[56:57], v16, s[4:7], s80 offen offset:0 sc1
    buffer_load_dwordx2 v[58:59], v16, s[4:7], s80 offen offset:128 sc1
    buffer_load_dwordx2 v[60:61], v16, s[4:7], s80 offen offset:256 sc1
    buffer_load_dwordx2 v[62:63], v16, s[4:7], s80 offen offset:384 sc1
    buffer_load_dwordx2 v[64:65], v16, s[4:7], s80 offen offset:512 sc1
    s_waitcnt vmcnt(0)
    s_branch L_a0c_58
L_a0r_59:
    s_add_u32 s67, s67, 1
    s_cmp_lt_u32 s67, 1048576
    s_cbranch_scc1 L_a0p_60
    s_branch L_a0k_61
L_fp_65:
    s_sleep 8
    buffer_load_dwordx2 v[220:221], v250, s[4:7], 0 offen sc1
    s_waitcnt vmcnt(0)
    s_branch L_fc_66
L_pad3_6:
    s_branch L_pad3_7
L_fr_67:
    s_add_u32 s67, s67, 1
    s_cmp_lt_u32 s67, 1048576
    s_cbranch_scc1 L_fp_65
    s_branch L_fk_68
L_slow_69:
    buffer_store_dwordx4 v[52:55], v29, s[4:7], s15 offen sc1
    s_branch L_pubd_70
L_slow_73:
    buffer_store_dword v40, v26, s[4:7], s75 offen sc1
    s_branch L_pubd_74
L_slow_75:
    buffer_store_dwordx2 v[40:41], v27, s[4:7], s76 offen sc1
    s_branch L_pubd_76
L_slow_77:
    buffer_store_dwordx4 v[44:47], v54, s[4:7], s70 offen sc1
    s_branch L_pubd_78
L_slow_79:
    buffer_store_dwordx4 v[48:51], v54, s[4:7], s70 offen sc1
    s_branch L_pubd_80
L_xgr_82:
    s_add_u32 s67, s67, 1
    s_cmp_lt_u32 s67, 1048576
    s_cbranch_scc1 L_xg_81
    s_branch L_xgk_83
L_ng_86:
    v_lshlrev_b32 v30, 16, v37
    v_and_b32 v31, 0xffff0000, v37
    v_add_f32 v44, v30, v31
    v_mul_f32 v45, v30, v30
    v_fmac_f32 v45, v31, v31
    s_nop 1
    v_permlane32_swap_b32 v44, v45
    v_add_f32 v44, v44, v45
    v_mov_b32 v45, s73
    s_nop 0
    v_add_f32_dpp v44, v44, v44 row_ror:8 row_mask:0xf bank_mask:0xf
    s_nop 1
    v_add_f32_dpp v44, v44, v44 row_ror:4 row_mask:0xf bank_mask:0xf
    s_nop 1
    v_add_f32_dpp v44, v44, v44 row_ror:2 row_mask:0xf bank_mask:0xf
    s_nop 1
    v_add_f32_dpp v44, v44, v44 row_ror:1 row_mask:0xf bank_mask:0xf
    s_nop 1
    v_add_f32_dpp v44, v44, v44 row_bcast:15 row_mask:0xa bank_mask:0xf
    s_cmp_eq_u32 s66, 0
    s_cbranch_scc1 L_slow_5087
    buffer_store_dwordx2 v[44:45], v15, s[4:7], 0 offen
L_pubd_5088:
    s_branch L_qg_h_done
L_slow_5087:
    buffer_store_dwordx2 v[44:45], v15, s[4:7], 0 offen sc1
    s_branch L_pubd_5088
L_slow_87:
    buffer_store_dwordx2 v[44:45], v15, s[4:7], 0 offen sc1
    s_branch L_pubd_88
L_pad3_7:
    s_branch L_pad3_8
L_slow_89:
    buffer_store_dwordx2 v[40:41], v13, s[4:7], s80 offen sc1
    s_branch L_pubd_90
L_slow_91:
    buffer_store_dword v52, v29, s[4:7], s15 offen offset:0 sc1
    s_branch L_pubd_92
L_qg_cs:
    v_and_b32 v54, 15, v1
    v_lshlrev_b32 v54, 3, v54
    s_mul_i32 s70, s58, 2560
    s_add_u32 s70, s70, 72704
    s_mul_i32 s71, s59, 640
    s_add_u32 s70, s70, s71
L_cs_7093:
    buffer_load_dwordx2 v[56:57], v54, s[4:7], s70 offen offset:0 sc1
    buffer_load_dwordx2 v[58:59], v54, s[4:7], s70 offen offset:128 sc1
    buffer_load_dwordx2 v[60:61], v54, s[4:7], s70 offen offset:256 sc1
    buffer_load_dwordx2 v[62:63], v54, s[4:7], s70 offen offset:384 sc1
    buffer_load_dwordx2 v[64:65], v54, s[4:7], s70 offen offset:512 sc1
    s_waitcnt vmcnt(3)
    v_xor_b32 v56, s26, v56
    v_xor_b32 v57, s26, v57
    v_xor_b32 v58, s26, v58
    v_xor_b32 v59, s26, v59
    v_pk_add_f32 v[246:247], v[56:57], v[58:59]
    v_or3_b32 v52, v56, v57, v58
    s_waitcnt vmcnt(2)
    v_xor_b32 v60, s26, v60
    v_xor_b32 v61, s26, v61
    v_pk_add_f32 v[246:247], v[246:247], v[60:61]
    v_or3_b32 v52, v52, v59, v60
    s_waitcnt vmcnt(1)
    v_xor_b32 v62, s26, v62
    v_xor_b32 v63, s26, v63
    v_pk_add_f32 v[246:247], v[246:247], v[62:63]
    v_or3_b32 v52, v52, v61, v62
    s_waitcnt vmcnt(0)
    v_xor_b32 v64, s26, v64
    v_xor_b32 v65, s26, v65
    v_or3_b32 v52, v52, v63, v64
    v_pk_add_f32 v[246:247], v[246:247], v[64:65]
    v_bitop3_b32 v52, v52, v65, v0 bitop3:0xa8
    v_cmp_ne_u32 vcc, 0, v52
    s_cbranch_vccnz L_csr_7094
L_csk_7095:
    s_branch L_qg_h
L_pad3_8:
    s_branch L_pad3_9
L_csr_7094:
    s_add_u32 s67, s67, 1
    s_cmp_lt_u32 s67, 1048576
    s_cbranch_scc1 L_cs_7093
    s_branch L_csk_7095
L_r5r_94:
    s_waitcnt lgkmcnt(0)
    v_cmp_lt_u32 vcc, s68, v53
    s_add_u32 s67, s67, 1
    s_cmp_lt_u32 s67, 1048576
    s_cbranch_vccnz L_qg_h_done
    s_cbranch_scc1 L_r5_93
    s_branch L_r5k_95
L_slow_97:
    buffer_store_dword v40, v249, s[4:7], s79 offen sc1
    s_branch L_pubd_98
L_csr_100:
    s_add_u32 s67, s67, 1
    s_cmp_lt_u32 s67, 1048576
    s_cbranch_scc1 L_cs_99
    s_branch L_csk_101
L_xgr_103:
    s_add_u32 s67, s67, 1
    s_cmp_lt_u32 s67, 1048576
    s_cbranch_scc1 L_xg_102
    s_branch L_xgk_104
L_slow_107:
    buffer_store_dwordx2 v[44:45], v15, s[4:7], 0 offen sc1
    s_branch L_pubd_108
L_slow_109:
    buffer_store_dwordx2 v[40:41], v13, s[4:7], s80 offen sc1
    s_branch L_pubd_110
L_csr_112:
    s_add_u32 s67, s67, 1
    s_cmp_lt_u32 s67, 1048576
    s_cbranch_scc1 L_cs_111
    s_branch L_csk_113
L_slow_119:
    buffer_store_dword v52, v29, s[4:7], s15 offen offset:0 sc1
    s_branch L_pubd_120
L_slow_123:
    buffer_store_dword v40, v26, s[4:7], s75 offen sc1
    s_branch L_pubd_124
L_slow_125:
    buffer_store_dwordx2 v[40:41], v27, s[4:7], s76 offen sc1
    s_branch L_pubd_126
L_xgr_128:
    s_add_u32 s67, s67, 1
    s_cmp_lt_u32 s67, 1048576
    s_cbranch_scc1 L_xg_127
    s_branch L_xgk_129
L_slow_134:
    buffer_store_dword v53, v29, s[4:7], s15 offen offset:512 sc1
    s_branch L_pubd_135
L_op_143:
    buffer_load_dword v54, v55, s[4:7], s15 offen sc1
    s_waitcnt vmcnt(0)
    s_branch L_oc_141
L_orr_142:
    s_add_u32 s67, s67, 1
    s_cmp_lt_u32 s67, 1048576
    s_cbranch_scc1 L_op_143
    s_branch L_ok_144
L_pad3_9:
    s_branch L_walk_back
L_slow_162:
    buffer_store_dword v42, v43, s[48:51], s70 offen sc1
    s_branch L_pubd_163
    s_endpgm
L_codeused:
.fill (4096 - ((L_codeused - L_pc) & 4095)) / 4, 4, 0xbf810000
L_codeend:
.section .rodata,"a"
.p2align 6
.amdhsa_kernel interleave_layers__sliding_block_cached__glu_gated_reglu__decode_kernel
  .amdhsa_next_free_vgpr 512
  .amdhsa_next_free_sgpr 96
  .amdhsa_accum_offset 256
  .amdhsa_group_segment_fixed_size 0
  .amdhsa_kernarg_size 96
  .amdhsa_user_sgpr_count 2
  .amdhsa_user_sgpr_kernarg_segment_ptr 1
  .amdhsa_system_sgpr_workgroup_id_x 1
  .amdhsa_float_denorm_mode_32 3
.end_amdhsa_kernel
```
